```python
import torch

def _softmax(x, axis=-1):
    return torch.softmax(x, dim=axis)

def _gelu(x):
    return torch.nn.functional.gelu(x, approximate='tanh')

def _silu(x):
    return torch.nn.functional.silu(x)

def _sigmoid(x):
    return torch.sigmoid(x)

def _layernorm(x, axis=-1, eps=1e-05):
    m = x.mean(dim=axis, keepdim=True)
    v = x.var(dim=axis, keepdim=True, unbiased=False)
    return (x - m) / torch.sqrt(v + eps)

def _scatter_add(tgt, idx, src, axis=0):
    return tgt.clone().index_add_(axis, idx, src)

def _segment_sum(src, seg, n):
    out = torch.zeros((n,) + src.shape[1:], dtype=src.dtype)
    return out.index_add_(0, seg, src)

def _pad(x, pw):
    flat = tuple((v for pair in reversed(pw) for v in pair))
    return torch.nn.functional.pad(x, flat)
kernel_name = 'adaLN_cond__mha_block_cached__geglu_ffn__decode'

def setup_inputs():

    _w = lambda a: (lambda t: t.to(torch.bfloat16) if t.is_floating_point() else t)(torch.as_tensor(a))

    def _A_setup():
        B, Sq, D = (2, 1, 448)
        H, Sk, Dh = (16, 4096, 256)
        return {'x': _w((lambda *s: torch.randn(*s, dtype=torch.bfloat16) * 0.1)(B, Sq, D)), 'k_cache': _w((lambda *s: torch.randn(*s, dtype=torch.bfloat16) * 0.8)(B, H, Sk, Dh)), 'v_cache': _w((lambda *s: torch.randn(*s, dtype=torch.bfloat16) * 0.8)(B, H, Sk, Dh)), 'wq': _w((lambda *s: torch.randn(*s, dtype=torch.bfloat16) * 0.8)(D, H * Dh) * D ** (-0.5)), 'wo': _w((lambda *s: torch.randn(*s, dtype=torch.bfloat16) * 0.8)(H * Dh, D) * (H * Dh) ** (-0.5))}
    _A_in = _A_setup()

    def _B_setup():
        B, S, D, F = (2, 1, 448, 1792)
        return {'x': _w((lambda *s: torch.randn(*s, dtype=torch.bfloat16) * 0.1)(B, S, D)), 'w_gate': _w((lambda *s: torch.randn(*s, dtype=torch.bfloat16) * 0.1)(D, F)), 'w_up': _w((lambda *s: torch.randn(*s, dtype=torch.bfloat16) * 0.1)(D, F)), 'w_down': _w((lambda *s: torch.randn(*s, dtype=torch.bfloat16) * 0.1)(F, D))}
    _B_in = _B_setup()
    return {'A_x': _A_in['x'], 'A_k_cache': _A_in['k_cache'], 'A_v_cache': _A_in['v_cache'], 'A_wq': _A_in['wq'], 'A_wo': _A_in['wo'], 'B_x': _B_in['x'], 'B_w_gate': _B_in['w_gate'], 'B_w_up': _B_in['w_up'], 'B_w_down': _B_in['w_down'], 'c': _w((lambda *s: torch.randn(*s, dtype=torch.bfloat16) * 0.8)(2, 448) * 8.0), 'w_mod': _w((lambda *s: torch.randn(*s, dtype=torch.bfloat16) * 0.8)(448, 6 * 448) * 448 ** (-0.5) * 8.0)}

def reference(A_x, A_k_cache, A_v_cache, A_wq, A_wo, B_x, B_w_gate, B_w_up, B_w_down, c, w_mod):

    def _A_ref(x, k_cache, v_cache, wq, wo):
        B, Sq, D = x.shape
        H, Dh = (16, 256)
        q = (lambda x, *d: x.permute(*d))((x @ wq).reshape(B, Sq, H, Dh), 0, 2, 1, 3)
        scores = torch.einsum('bhqd,bhkd->bhqk', q, k_cache) * Dh ** (-0.5)
        p = _softmax(scores, axis=-1)
        o = torch.einsum('bhqk,bhkd->bhqd', p, v_cache)
        return (lambda x, *d: x.permute(*d))(o, 0, 2, 1, 3).reshape(B, Sq, H * Dh) @ wo

    def _B_ref(x, w_gate, w_up, w_down):
        return _gelu(x @ w_gate) * (x @ w_up) @ w_down
    x = A_x
    mod = (_silu(c) @ w_mod).reshape(c.shape[0], 6, 1, -1)
    sa, ca, ga, sb, cb, gb = (mod[:, 0].clone(), mod[:, 1].clone(), mod[:, 2].clone(), mod[:, 3].clone(), mod[:, 4].clone(), mod[:, 5].clone())
    h = _layernorm(x, axis=-1) * (1 + ca) + sa
    x = x + ga * _A_ref(h, A_k_cache, A_v_cache, A_wq, A_wo)
    h = _layernorm(x, axis=-1) * (1 + cb) + sb
    x = x + gb * _B_ref(h, B_w_gate, B_w_up, B_w_down)
    return x
```

```asm
; @launch grid=(256,1,1) block=(1024,1,1) lds=163840
.amdgcn_target "amdgcn-amd-amdhsa--gfx950"
.text
.globl adaLN_cond__mha_block_cached__geglu_ffn__decode_kernel
.p2align 8
.type adaLN_cond__mha_block_cached__geglu_ffn__decode_kernel,@function
adaLN_cond__mha_block_cached__geglu_ffn__decode_kernel:
  s_cmp_ge_u32 s2, 256
  s_cbranch_scc1 L_end
  s_load_dwordx16 s[16:31], s[0:1], 0
  s_load_dwordx8 s[32:39], s[0:1], 64
  s_load_dwordx4 s[40:43], s[0:1], 96
  v_lshrrev_b32 v1, 6, v0
  v_and_b32 v2, 63, v0
  v_readfirstlane_b32 s3, v1
  s_mov_b32 s94, 0xfffffffe
  s_mov_b32 s95, 0x05040100
  s_mov_b32 s96, 0x07060302
  s_waitcnt lgkmcnt(0)
  s_cmp_lt_u32 s2, 32
  s_cbranch_scc1 L_service
  s_sub_u32 s4, s2, 32
  s_mul_i32 s5, s4, 9363
  s_lshr_b32 s5, s5, 16
  s_mul_i32 s6, s5, 7
  s_sub_u32 s6, s4, s6
  s_cmp_eq_u32 s3, 15
  s_cbranch_scc1 L_ctrl
  s_barrier
  s_mov_b32 s44, s18
  s_and_b32 s45, s19, 0xffff
  s_mov_b32 s46, 67108864
  s_mov_b32 s47, 0x20000
  s_mov_b32 s48, s20
  s_and_b32 s49, s21, 0xffff
  s_mov_b32 s50, 67108864
  s_mov_b32 s51, 0x20000
  s_mul_i32 s7, s6, 15
  s_add_u32 s7, s7, s3
  s_lshl_b32 s8, s7, 11
  s_mov_b32 s9, 40904451
  s_mul_hi_u32 s10, s8, s9
  s_add_u32 s8, s8, 2048
  s_mul_hi_u32 s11, s8, s9
  s_sub_u32 s11, s11, s10
  s_lshl_b32 s12, s5, 21
  s_lshl_b32 s13, s10, 10
  s_add_u32 s12, s12, s13
  v_lshlrev_b32 v3, 4, v2
  v_add_u32 v1, s12, v3
  s_mov_b32 s60, 4096
  s_mov_b32 s61, 8192
  s_mov_b32 s62, 12288
  s_mov_b32 s63, 16384
  s_mov_b32 s64, 0x40000000
  s_mov_b32 s65, 0xff800000
  s_cmp_eq_u32 s11, 20
  s_cselect_b32 s64, s63, s64
  s_cselect_b32 s65, 0, s65
  buffer_load_dwordx4 v[8:11], v1, s[44:47], 0 offen offset:0 nt
  buffer_load_dwordx4 v[12:15], v1, s[44:47], 0 offen offset:1024 nt
  buffer_load_dwordx4 v[16:19], v1, s[44:47], 0 offen offset:2048 nt
  buffer_load_dwordx4 v[20:23], v1, s[44:47], 0 offen offset:3072 nt
  buffer_load_dwordx4 v[24:27], v1, s[44:47], s60 offen offset:0 nt
  buffer_load_dwordx4 v[28:31], v1, s[44:47], s60 offen offset:1024 nt
  buffer_load_dwordx4 v[32:35], v1, s[44:47], s60 offen offset:2048 nt
  buffer_load_dwordx4 v[36:39], v1, s[44:47], s60 offen offset:3072 nt
  buffer_load_dwordx4 v[40:43], v1, s[44:47], s61 offen offset:0 nt
  buffer_load_dwordx4 v[44:47], v1, s[44:47], s61 offen offset:1024 nt
  buffer_load_dwordx4 v[48:51], v1, s[44:47], s61 offen offset:2048 nt
  buffer_load_dwordx4 v[52:55], v1, s[44:47], s61 offen offset:3072 nt
  buffer_load_dwordx4 v[56:59], v1, s[44:47], s62 offen offset:0 nt
  buffer_load_dwordx4 v[60:63], v1, s[44:47], s62 offen offset:1024 nt
  buffer_load_dwordx4 v[64:67], v1, s[44:47], s62 offen offset:2048 nt
  buffer_load_dwordx4 v[68:71], v1, s[44:47], s62 offen offset:3072 nt
  buffer_load_dwordx4 v[72:75], v1, s[44:47], s63 offen offset:0 nt
  buffer_load_dwordx4 v[76:79], v1, s[44:47], s63 offen offset:1024 nt
  buffer_load_dwordx4 v[80:83], v1, s[44:47], s63 offen offset:2048 nt
  buffer_load_dwordx4 v[84:87], v1, s[44:47], s64 offen offset:3072 nt
  buffer_load_dwordx4 v[88:91], v1, s[48:51], 0 offen offset:0 nt
  buffer_load_dwordx4 v[92:95], v1, s[48:51], 0 offen offset:1024 nt
  buffer_load_dwordx4 v[96:99], v1, s[48:51], 0 offen offset:2048 nt
  buffer_load_dwordx4 v[100:103], v1, s[48:51], 0 offen offset:3072 nt
  buffer_load_dwordx4 v[104:107], v1, s[48:51], s60 offen offset:0 nt
  buffer_load_dwordx4 v[108:111], v1, s[48:51], s60 offen offset:1024 nt
  buffer_load_dwordx4 v[112:115], v1, s[48:51], s60 offen offset:2048 nt
  s_lshl_b32 s14, s3, 13
  s_add_u32 s14, s14, 33792
  s_add_u32 s15, s14, 1024
  s_sub_u32 m0, s15, 4096
  s_nop 0
  buffer_load_dwordx4 v1, s[48:51], s60 offen offset:3072 nt lds
  s_add_u32 s15, s14, 5120
  s_sub_u32 m0, s15, 4096
  s_nop 0
  buffer_load_dwordx4 v1, s[48:51], s61 offen offset:0 nt lds
  s_add_u32 s15, s14, 5120
  s_sub_u32 m0, s15, 4096
  s_nop 0
  buffer_load_dwordx4 v1, s[48:51], s61 offen offset:1024 nt lds
  s_add_u32 s15, s14, 5120
  s_sub_u32 m0, s15, 4096
  s_nop 0
  buffer_load_dwordx4 v1, s[48:51], s61 offen offset:2048 nt lds
  s_add_u32 s15, s14, 5120
  s_sub_u32 m0, s15, 4096
  s_nop 0
  buffer_load_dwordx4 v1, s[48:51], s61 offen offset:3072 nt lds
  s_add_u32 s15, s14, 9216
  s_sub_u32 m0, s15, 4096
  s_nop 0
  buffer_load_dwordx4 v1, s[48:51], s62 offen offset:0 nt lds
  s_add_u32 s15, s14, 9216
  s_sub_u32 m0, s15, 4096
  s_nop 0
  buffer_load_dwordx4 v1, s[48:51], s62 offen offset:1024 nt lds
  s_add_u32 s15, s14, 9216
  s_sub_u32 m0, s15, 4096
  s_nop 0
  buffer_load_dwordx4 v1, s[48:51], s62 offen offset:2048 nt lds
  v_mov_b32 v3, 0
  s_mov_b32 s90, 0
  s_nop 4
L_qf:
  ds_read_b32 v4, v3 offset:1020
  s_waitcnt lgkmcnt(0)
  v_readfirstlane_b32 s7, v4
  s_nop 0
  s_cmp_eq_u32 s7, 1
  s_cbranch_scc1 L_qfd
  s_add_u32 s90, s90, 1
  s_cmp_ge_u32 s90, 2000000
  s_cbranch_scc1 L_qfd
  s_sleep 2
  s_branch L_qf
  s_nop 4
L_qfd:
  v_and_b32 v3, 31, v2
  v_lshlrev_b32 v3, 4, v3
  ds_read_b128 v[4:7], v3
  s_waitcnt lgkmcnt(0)
  s_waitcnt vmcnt(31)
  v_dot2_f32_bf16 v8, v8, v4, 0
  v_dot2_f32_bf16 v8, v9, v5, v8
  v_dot2_f32_bf16 v8, v10, v6, v8
  v_dot2_f32_bf16 v8, v11, v7, v8
  v_dot2_f32_bf16 v9, v12, v4, 0
  v_dot2_f32_bf16 v10, v16, v4, 0
  v_dot2_f32_bf16 v11, v20, v4, 0
  v_dot2_f32_bf16 v9, v13, v5, v9
  v_dot2_f32_bf16 v10, v17, v5, v10
  v_dot2_f32_bf16 v11, v21, v5, v11
  v_dot2_f32_bf16 v9, v14, v6, v9
  v_dot2_f32_bf16 v10, v18, v6, v10
  v_dot2_f32_bf16 v11, v22, v6, v11
  v_dot2_f32_bf16 v9, v15, v7, v9
  v_dot2_f32_bf16 v10, v19, v7, v10
  v_dot2_f32_bf16 v11, v23, v7, v11
  v_add_f32_dpp v8, v8, v8 quad_perm:[1,0,3,2] row_mask:0xf bank_mask:0xf
  v_add_f32_dpp v9, v9, v9 quad_perm:[1,0,3,2] row_mask:0xf bank_mask:0xf
  v_add_f32_dpp v10, v10, v10 quad_perm:[1,0,3,2] row_mask:0xf bank_mask:0xf
  v_add_f32_dpp v11, v11, v11 quad_perm:[1,0,3,2] row_mask:0xf bank_mask:0xf
  v_add_f32_dpp v8, v8, v8 quad_perm:[2,3,0,1] row_mask:0xf bank_mask:0xf
  v_add_f32_dpp v9, v9, v9 quad_perm:[2,3,0,1] row_mask:0xf bank_mask:0xf
  v_add_f32_dpp v10, v10, v10 quad_perm:[2,3,0,1] row_mask:0xf bank_mask:0xf
  v_add_f32_dpp v11, v11, v11 quad_perm:[2,3,0,1] row_mask:0xf bank_mask:0xf
  v_add_f32_dpp v8, v8, v8 row_half_mirror row_mask:0xf bank_mask:0xf
  v_add_f32_dpp v9, v9, v9 row_half_mirror row_mask:0xf bank_mask:0xf
  v_add_f32_dpp v10, v10, v10 row_half_mirror row_mask:0xf bank_mask:0xf
  v_add_f32_dpp v11, v11, v11 row_half_mirror row_mask:0xf bank_mask:0xf
  v_add_f32_dpp v8, v8, v8 row_mirror row_mask:0xf bank_mask:0xf
  v_add_f32_dpp v9, v9, v9 row_mirror row_mask:0xf bank_mask:0xf
  v_add_f32_dpp v10, v10, v10 row_mirror row_mask:0xf bank_mask:0xf
  v_add_f32_dpp v11, v11, v11 row_mirror row_mask:0xf bank_mask:0xf
  v_mov_b32 v116, v8
  v_mov_b32 v117, v9
  v_mov_b32 v118, v10
  v_mov_b32 v119, v11
  v_permlane16_swap_b32 v8, v116
  v_permlane16_swap_b32 v9, v117
  v_permlane16_swap_b32 v10, v118
  v_permlane16_swap_b32 v11, v119
  v_add_f32 v8, v8, v116
  v_add_f32 v9, v9, v117
  v_add_f32 v10, v10, v118
  v_add_f32 v11, v11, v119
  v_cvt_pk_bf16_f32 v8, v8, v8
  v_cvt_pk_bf16_f32 v9, v9, v9
  v_cvt_pk_bf16_f32 v10, v10, v10
  v_cvt_pk_bf16_f32 v11, v11, v11
  v_lshlrev_b32 v8, 16, v8
  v_lshlrev_b32 v9, 16, v9
  v_lshlrev_b32 v10, 16, v10
  v_lshlrev_b32 v11, 16, v11
  v_mul_f32 v8, 0x3db8aa3b, v8
  v_mul_f32 v9, 0x3db8aa3b, v9
  v_mul_f32 v10, 0x3db8aa3b, v10
  v_mul_f32 v11, 0x3db8aa3b, v11
  s_waitcnt vmcnt(27)
  v_dot2_f32_bf16 v12, v24, v4, 0
  v_dot2_f32_bf16 v13, v28, v4, 0
  v_dot2_f32_bf16 v14, v32, v4, 0
  v_dot2_f32_bf16 v15, v36, v4, 0
  v_dot2_f32_bf16 v12, v25, v5, v12
  v_dot2_f32_bf16 v13, v29, v5, v13
  v_dot2_f32_bf16 v14, v33, v5, v14
  v_dot2_f32_bf16 v15, v37, v5, v15
  v_dot2_f32_bf16 v12, v26, v6, v12
  v_dot2_f32_bf16 v13, v30, v6, v13
  v_dot2_f32_bf16 v14, v34, v6, v14
  v_dot2_f32_bf16 v15, v38, v6, v15
  v_dot2_f32_bf16 v12, v27, v7, v12
  v_dot2_f32_bf16 v13, v31, v7, v13
  v_dot2_f32_bf16 v14, v35, v7, v14
  v_dot2_f32_bf16 v15, v39, v7, v15
  v_add_f32_dpp v12, v12, v12 quad_perm:[1,0,3,2] row_mask:0xf bank_mask:0xf
  v_add_f32_dpp v13, v13, v13 quad_perm:[1,0,3,2] row_mask:0xf bank_mask:0xf
  v_add_f32_dpp v14, v14, v14 quad_perm:[1,0,3,2] row_mask:0xf bank_mask:0xf
  v_add_f32_dpp v15, v15, v15 quad_perm:[1,0,3,2] row_mask:0xf bank_mask:0xf
  v_add_f32_dpp v12, v12, v12 quad_perm:[2,3,0,1] row_mask:0xf bank_mask:0xf
  v_add_f32_dpp v13, v13, v13 quad_perm:[2,3,0,1] row_mask:0xf bank_mask:0xf
  v_add_f32_dpp v14, v14, v14 quad_perm:[2,3,0,1] row_mask:0xf bank_mask:0xf
  v_add_f32_dpp v15, v15, v15 quad_perm:[2,3,0,1] row_mask:0xf bank_mask:0xf
  v_add_f32_dpp v12, v12, v12 row_half_mirror row_mask:0xf bank_mask:0xf
  v_add_f32_dpp v13, v13, v13 row_half_mirror row_mask:0xf bank_mask:0xf
  v_add_f32_dpp v14, v14, v14 row_half_mirror row_mask:0xf bank_mask:0xf
  v_add_f32_dpp v15, v15, v15 row_half_mirror row_mask:0xf bank_mask:0xf
  v_add_f32_dpp v12, v12, v12 row_mirror row_mask:0xf bank_mask:0xf
  v_add_f32_dpp v13, v13, v13 row_mirror row_mask:0xf bank_mask:0xf
  v_add_f32_dpp v14, v14, v14 row_mirror row_mask:0xf bank_mask:0xf
  v_add_f32_dpp v15, v15, v15 row_mirror row_mask:0xf bank_mask:0xf
  v_mov_b32 v116, v12
  v_mov_b32 v117, v13
  v_mov_b32 v118, v14
  v_mov_b32 v119, v15
  v_permlane16_swap_b32 v12, v116
  v_permlane16_swap_b32 v13, v117
  v_permlane16_swap_b32 v14, v118
  v_permlane16_swap_b32 v15, v119
  v_add_f32 v12, v12, v116
  v_add_f32 v13, v13, v117
  v_add_f32 v14, v14, v118
  v_add_f32 v15, v15, v119
  v_cvt_pk_bf16_f32 v12, v12, v12
  v_cvt_pk_bf16_f32 v13, v13, v13
  v_cvt_pk_bf16_f32 v14, v14, v14
  v_cvt_pk_bf16_f32 v15, v15, v15
  v_lshlrev_b32 v12, 16, v12
  v_lshlrev_b32 v13, 16, v13
  v_lshlrev_b32 v14, 16, v14
  v_lshlrev_b32 v15, 16, v15
  v_mul_f32 v12, 0x3db8aa3b, v12
  v_mul_f32 v13, 0x3db8aa3b, v13
  v_mul_f32 v14, 0x3db8aa3b, v14
  v_mul_f32 v15, 0x3db8aa3b, v15
  s_waitcnt vmcnt(23)
  v_dot2_f32_bf16 v16, v40, v4, 0
  v_dot2_f32_bf16 v17, v44, v4, 0
  v_dot2_f32_bf16 v18, v48, v4, 0
  v_dot2_f32_bf16 v19, v52, v4, 0
  v_dot2_f32_bf16 v16, v41, v5, v16
  v_dot2_f32_bf16 v17, v45, v5, v17
  v_dot2_f32_bf16 v18, v49, v5, v18
  v_dot2_f32_bf16 v19, v53, v5, v19
  v_dot2_f32_bf16 v16, v42, v6, v16
  v_dot2_f32_bf16 v17, v46, v6, v17
  v_dot2_f32_bf16 v18, v50, v6, v18
  v_dot2_f32_bf16 v19, v54, v6, v19
  v_dot2_f32_bf16 v16, v43, v7, v16
  v_dot2_f32_bf16 v17, v47, v7, v17
  v_dot2_f32_bf16 v18, v51, v7, v18
  v_dot2_f32_bf16 v19, v55, v7, v19
  v_add_f32_dpp v16, v16, v16 quad_perm:[1,0,3,2] row_mask:0xf bank_mask:0xf
  v_add_f32_dpp v17, v17, v17 quad_perm:[1,0,3,2] row_mask:0xf bank_mask:0xf
  v_add_f32_dpp v18, v18, v18 quad_perm:[1,0,3,2] row_mask:0xf bank_mask:0xf
  v_add_f32_dpp v19, v19, v19 quad_perm:[1,0,3,2] row_mask:0xf bank_mask:0xf
  v_add_f32_dpp v16, v16, v16 quad_perm:[2,3,0,1] row_mask:0xf bank_mask:0xf
  v_add_f32_dpp v17, v17, v17 quad_perm:[2,3,0,1] row_mask:0xf bank_mask:0xf
  v_add_f32_dpp v18, v18, v18 quad_perm:[2,3,0,1] row_mask:0xf bank_mask:0xf
  v_add_f32_dpp v19, v19, v19 quad_perm:[2,3,0,1] row_mask:0xf bank_mask:0xf
  v_add_f32_dpp v16, v16, v16 row_half_mirror row_mask:0xf bank_mask:0xf
  v_add_f32_dpp v17, v17, v17 row_half_mirror row_mask:0xf bank_mask:0xf
  v_add_f32_dpp v18, v18, v18 row_half_mirror row_mask:0xf bank_mask:0xf
  v_add_f32_dpp v19, v19, v19 row_half_mirror row_mask:0xf bank_mask:0xf
  v_add_f32_dpp v16, v16, v16 row_mirror row_mask:0xf bank_mask:0xf
  v_add_f32_dpp v17, v17, v17 row_mirror row_mask:0xf bank_mask:0xf
  v_add_f32_dpp v18, v18, v18 row_mirror row_mask:0xf bank_mask:0xf
  v_add_f32_dpp v19, v19, v19 row_mirror row_mask:0xf bank_mask:0xf
  v_mov_b32 v116, v16
  v_mov_b32 v117, v17
  v_mov_b32 v118, v18
  v_mov_b32 v119, v19
  v_permlane16_swap_b32 v16, v116
  v_permlane16_swap_b32 v17, v117
  v_permlane16_swap_b32 v18, v118
  v_permlane16_swap_b32 v19, v119
  v_add_f32 v16, v16, v116
  v_add_f32 v17, v17, v117
  v_add_f32 v18, v18, v118
  v_add_f32 v19, v19, v119
  v_cvt_pk_bf16_f32 v16, v16, v16
  v_cvt_pk_bf16_f32 v17, v17, v17
  v_cvt_pk_bf16_f32 v18, v18, v18
  v_cvt_pk_bf16_f32 v19, v19, v19
  v_lshlrev_b32 v16, 16, v16
  v_lshlrev_b32 v17, 16, v17
  v_lshlrev_b32 v18, 16, v18
  v_lshlrev_b32 v19, 16, v19
  v_mul_f32 v16, 0x3db8aa3b, v16
  v_mul_f32 v17, 0x3db8aa3b, v17
  v_mul_f32 v18, 0x3db8aa3b, v18
  v_mul_f32 v19, 0x3db8aa3b, v19
  s_waitcnt vmcnt(19)
  v_dot2_f32_bf16 v20, v56, v4, 0
  v_dot2_f32_bf16 v21, v60, v4, 0
  v_dot2_f32_bf16 v22, v64, v4, 0
  v_dot2_f32_bf16 v23, v68, v4, 0
  v_dot2_f32_bf16 v20, v57, v5, v20
  v_dot2_f32_bf16 v21, v61, v5, v21
  v_dot2_f32_bf16 v22, v65, v5, v22
  v_dot2_f32_bf16 v23, v69, v5, v23
  v_dot2_f32_bf16 v20, v58, v6, v20
  v_dot2_f32_bf16 v21, v62, v6, v21
  v_dot2_f32_bf16 v22, v66, v6, v22
  v_dot2_f32_bf16 v23, v70, v6, v23
  v_dot2_f32_bf16 v20, v59, v7, v20
  v_dot2_f32_bf16 v21, v63, v7, v21
  v_dot2_f32_bf16 v22, v67, v7, v22
  v_dot2_f32_bf16 v23, v71, v7, v23
  buffer_load_dwordx4 v[60:63], v1, s[48:51], s62 offen offset:3072 nt
  buffer_load_dwordx4 v[64:67], v1, s[48:51], s63 offen offset:0 nt
  buffer_load_dwordx4 v[68:71], v1, s[48:51], s63 offen offset:1024 nt
  v_add_f32_dpp v20, v20, v20 quad_perm:[1,0,3,2] row_mask:0xf bank_mask:0xf
  v_add_f32_dpp v21, v21, v21 quad_perm:[1,0,3,2] row_mask:0xf bank_mask:0xf
  v_add_f32_dpp v22, v22, v22 quad_perm:[1,0,3,2] row_mask:0xf bank_mask:0xf
  v_add_f32_dpp v23, v23, v23 quad_perm:[1,0,3,2] row_mask:0xf bank_mask:0xf
  v_add_f32_dpp v20, v20, v20 quad_perm:[2,3,0,1] row_mask:0xf bank_mask:0xf
  v_add_f32_dpp v21, v21, v21 quad_perm:[2,3,0,1] row_mask:0xf bank_mask:0xf
  v_add_f32_dpp v22, v22, v22 quad_perm:[2,3,0,1] row_mask:0xf bank_mask:0xf
  v_add_f32_dpp v23, v23, v23 quad_perm:[2,3,0,1] row_mask:0xf bank_mask:0xf
  v_add_f32_dpp v20, v20, v20 row_half_mirror row_mask:0xf bank_mask:0xf
  v_add_f32_dpp v21, v21, v21 row_half_mirror row_mask:0xf bank_mask:0xf
  v_add_f32_dpp v22, v22, v22 row_half_mirror row_mask:0xf bank_mask:0xf
  v_add_f32_dpp v23, v23, v23 row_half_mirror row_mask:0xf bank_mask:0xf
  v_add_f32_dpp v20, v20, v20 row_mirror row_mask:0xf bank_mask:0xf
  v_add_f32_dpp v21, v21, v21 row_mirror row_mask:0xf bank_mask:0xf
  v_add_f32_dpp v22, v22, v22 row_mirror row_mask:0xf bank_mask:0xf
  v_add_f32_dpp v23, v23, v23 row_mirror row_mask:0xf bank_mask:0xf
  v_mov_b32 v116, v20
  v_mov_b32 v117, v21
  v_mov_b32 v118, v22
  v_mov_b32 v119, v23
  v_permlane16_swap_b32 v20, v116
  v_permlane16_swap_b32 v21, v117
  v_permlane16_swap_b32 v22, v118
  v_permlane16_swap_b32 v23, v119
  v_add_f32 v20, v20, v116
  v_add_f32 v21, v21, v117
  v_add_f32 v22, v22, v118
  v_add_f32 v23, v23, v119
  v_cvt_pk_bf16_f32 v20, v20, v20
  v_cvt_pk_bf16_f32 v21, v21, v21
  v_cvt_pk_bf16_f32 v22, v22, v22
  v_cvt_pk_bf16_f32 v23, v23, v23
  v_lshlrev_b32 v20, 16, v20
  v_lshlrev_b32 v21, 16, v21
  v_lshlrev_b32 v22, 16, v22
  v_lshlrev_b32 v23, 16, v23
  v_mul_f32 v20, 0x3db8aa3b, v20
  v_mul_f32 v21, 0x3db8aa3b, v21
  v_mul_f32 v22, 0x3db8aa3b, v22
  v_mul_f32 v23, 0x3db8aa3b, v23
  s_waitcnt vmcnt(18)
  v_dot2_f32_bf16 v24, v72, v4, 0
  v_dot2_f32_bf16 v25, v76, v4, 0
  v_dot2_f32_bf16 v26, v80, v4, 0
  v_dot2_f32_bf16 v27, v84, v4, 0
  v_dot2_f32_bf16 v24, v73, v5, v24
  v_dot2_f32_bf16 v25, v77, v5, v25
  v_dot2_f32_bf16 v26, v81, v5, v26
  v_dot2_f32_bf16 v27, v85, v5, v27
  v_dot2_f32_bf16 v24, v74, v6, v24
  v_dot2_f32_bf16 v25, v78, v6, v25
  v_dot2_f32_bf16 v26, v82, v6, v26
  v_dot2_f32_bf16 v27, v86, v6, v27
  v_dot2_f32_bf16 v24, v75, v7, v24
  v_dot2_f32_bf16 v25, v79, v7, v25
  v_dot2_f32_bf16 v26, v83, v7, v26
  v_dot2_f32_bf16 v27, v87, v7, v27
  buffer_load_dwordx4 v[72:75], v1, s[48:51], s63 offen offset:2048 nt
  buffer_load_dwordx4 v[76:79], v1, s[48:51], s64 offen offset:3072 nt
  v_add_f32_dpp v24, v24, v24 quad_perm:[1,0,3,2] row_mask:0xf bank_mask:0xf
  v_add_f32_dpp v25, v25, v25 quad_perm:[1,0,3,2] row_mask:0xf bank_mask:0xf
  v_add_f32_dpp v26, v26, v26 quad_perm:[1,0,3,2] row_mask:0xf bank_mask:0xf
  v_add_f32_dpp v27, v27, v27 quad_perm:[1,0,3,2] row_mask:0xf bank_mask:0xf
  v_add_f32_dpp v24, v24, v24 quad_perm:[2,3,0,1] row_mask:0xf bank_mask:0xf
  v_add_f32_dpp v25, v25, v25 quad_perm:[2,3,0,1] row_mask:0xf bank_mask:0xf
  v_add_f32_dpp v26, v26, v26 quad_perm:[2,3,0,1] row_mask:0xf bank_mask:0xf
  v_add_f32_dpp v27, v27, v27 quad_perm:[2,3,0,1] row_mask:0xf bank_mask:0xf
  v_add_f32_dpp v24, v24, v24 row_half_mirror row_mask:0xf bank_mask:0xf
  v_add_f32_dpp v25, v25, v25 row_half_mirror row_mask:0xf bank_mask:0xf
  v_add_f32_dpp v26, v26, v26 row_half_mirror row_mask:0xf bank_mask:0xf
  v_add_f32_dpp v27, v27, v27 row_half_mirror row_mask:0xf bank_mask:0xf
  v_add_f32_dpp v24, v24, v24 row_mirror row_mask:0xf bank_mask:0xf
  v_add_f32_dpp v25, v25, v25 row_mirror row_mask:0xf bank_mask:0xf
  v_add_f32_dpp v26, v26, v26 row_mirror row_mask:0xf bank_mask:0xf
  v_add_f32_dpp v27, v27, v27 row_mirror row_mask:0xf bank_mask:0xf
  v_mov_b32 v116, v24
  v_mov_b32 v117, v25
  v_mov_b32 v118, v26
  v_mov_b32 v119, v27
  v_permlane16_swap_b32 v24, v116
  v_permlane16_swap_b32 v25, v117
  v_permlane16_swap_b32 v26, v118
  v_permlane16_swap_b32 v27, v119
  v_add_f32 v24, v24, v116
  v_add_f32 v25, v25, v117
  v_add_f32 v26, v26, v118
  v_add_f32 v27, v27, v119
  v_cvt_pk_bf16_f32 v24, v24, v24
  v_cvt_pk_bf16_f32 v25, v25, v25
  v_cvt_pk_bf16_f32 v26, v26, v26
  v_cvt_pk_bf16_f32 v27, v27, v27
  v_lshlrev_b32 v24, 16, v24
  v_lshlrev_b32 v25, 16, v25
  v_lshlrev_b32 v26, 16, v26
  v_lshlrev_b32 v27, 16, v27
  v_mul_f32 v24, 0x3db8aa3b, v24
  v_mul_f32 v25, 0x3db8aa3b, v25
  v_mul_f32 v26, 0x3db8aa3b, v26
  v_mul_f32 v27, 0x3db8aa3b, v27
  v_add_f32 v27, s65, v27
  v_max3_f32 v4, v8, v9, v10
  v_max3_f32 v4, v4, v11, v12
  v_max3_f32 v4, v4, v13, v14
  v_max3_f32 v4, v4, v15, v16
  v_max3_f32 v4, v4, v17, v18
  v_max3_f32 v4, v4, v19, v20
  v_max3_f32 v4, v4, v21, v22
  v_max3_f32 v4, v4, v23, v24
  v_max3_f32 v4, v4, v25, v26
  v_max_f32 v4, v4, v27
  v_sub_f32 v8, v8, v4
  v_sub_f32 v9, v9, v4
  v_sub_f32 v10, v10, v4
  v_sub_f32 v11, v11, v4
  v_sub_f32 v12, v12, v4
  v_sub_f32 v13, v13, v4
  v_sub_f32 v14, v14, v4
  v_sub_f32 v15, v15, v4
  v_sub_f32 v16, v16, v4
  v_sub_f32 v17, v17, v4
  v_sub_f32 v18, v18, v4
  v_sub_f32 v19, v19, v4
  v_sub_f32 v20, v20, v4
  v_sub_f32 v21, v21, v4
  v_sub_f32 v22, v22, v4
  v_sub_f32 v23, v23, v4
  v_sub_f32 v24, v24, v4
  v_sub_f32 v25, v25, v4
  v_sub_f32 v26, v26, v4
  v_sub_f32 v27, v27, v4
  v_exp_f32 v8, v8
  v_exp_f32 v9, v9
  v_exp_f32 v10, v10
  v_exp_f32 v11, v11
  v_exp_f32 v12, v12
  v_exp_f32 v13, v13
  v_exp_f32 v14, v14
  v_exp_f32 v15, v15
  v_exp_f32 v16, v16
  v_exp_f32 v17, v17
  v_exp_f32 v18, v18
  v_exp_f32 v19, v19
  v_exp_f32 v20, v20
  v_exp_f32 v21, v21
  v_exp_f32 v22, v22
  v_exp_f32 v23, v23
  v_exp_f32 v24, v24
  v_exp_f32 v25, v25
  v_exp_f32 v26, v26
  v_exp_f32 v27, v27
  v_add_f32 v5, v8, v9
  v_add_f32 v5, v5, v10
  v_add_f32 v5, v5, v11
  v_add_f32 v5, v5, v12
  v_add_f32 v5, v5, v13
  v_add_f32 v5, v5, v14
  v_add_f32 v5, v5, v15
  v_add_f32 v5, v5, v16
  v_add_f32 v5, v5, v17
  v_add_f32 v5, v5, v18
  v_add_f32 v5, v5, v19
  v_add_f32 v5, v5, v20
  v_add_f32 v5, v5, v21
  v_add_f32 v5, v5, v22
  v_add_f32 v5, v5, v23
  v_add_f32 v5, v5, v24
  v_add_f32 v5, v5, v25
  v_add_f32 v5, v5, v26
  v_add_f32 v5, v5, v27
  v_cvt_pk_bf16_f32 v8, v8, 0
  v_cvt_pk_bf16_f32 v9, v9, 0
  v_cvt_pk_bf16_f32 v10, v10, 0
  v_cvt_pk_bf16_f32 v11, v11, 0
  v_cvt_pk_bf16_f32 v12, v12, 0
  v_cvt_pk_bf16_f32 v13, v13, 0
  v_cvt_pk_bf16_f32 v14, v14, 0
  v_cvt_pk_bf16_f32 v15, v15, 0
  v_cvt_pk_bf16_f32 v16, v16, 0
  v_cvt_pk_bf16_f32 v17, v17, 0
  v_cvt_pk_bf16_f32 v18, v18, 0
  v_cvt_pk_bf16_f32 v19, v19, 0
  v_cvt_pk_bf16_f32 v20, v20, 0
  v_cvt_pk_bf16_f32 v21, v21, 0
  v_cvt_pk_bf16_f32 v22, v22, 0
  v_cvt_pk_bf16_f32 v23, v23, 0
  v_cvt_pk_bf16_f32 v24, v24, 0
  v_cvt_pk_bf16_f32 v25, v25, 0
  v_cvt_pk_bf16_f32 v26, v26, 0
  v_cvt_pk_bf16_f32 v27, v27, 0
  v_mov_b32 v120, 0
  v_mov_b32 v121, 0
  v_mov_b32 v122, 0
  v_mov_b32 v123, 0
  v_mov_b32 v124, 0
  v_mov_b32 v125, 0
  v_mov_b32 v126, 0
  v_mov_b32 v127, 0
  v_lshlrev_b32 v6, 4, v2
  v_add_u32 v6, s14, v6
  s_waitcnt vmcnt(19)
  v_lshlrev_b32 v116, 16, v8
  v_dot2_f32_bf16 v120, v88, v8, v120
  v_dot2_f32_bf16 v121, v88, v116, v121
  v_dot2_f32_bf16 v122, v89, v8, v122
  v_dot2_f32_bf16 v123, v89, v116, v123
  v_dot2_f32_bf16 v124, v90, v8, v124
  v_dot2_f32_bf16 v125, v90, v116, v125
  v_dot2_f32_bf16 v126, v91, v8, v126
  v_dot2_f32_bf16 v127, v91, v116, v127
  s_waitcnt vmcnt(18)
  v_lshlrev_b32 v117, 16, v9
  v_dot2_f32_bf16 v120, v92, v9, v120
  v_dot2_f32_bf16 v121, v92, v117, v121
  v_dot2_f32_bf16 v122, v93, v9, v122
  v_dot2_f32_bf16 v123, v93, v117, v123
  v_dot2_f32_bf16 v124, v94, v9, v124
  v_dot2_f32_bf16 v125, v94, v117, v125
  v_dot2_f32_bf16 v126, v95, v9, v126
  v_dot2_f32_bf16 v127, v95, v117, v127
  s_waitcnt vmcnt(17)
  v_lshlrev_b32 v116, 16, v10
  v_dot2_f32_bf16 v120, v96, v10, v120
  v_dot2_f32_bf16 v121, v96, v116, v121
  v_dot2_f32_bf16 v122, v97, v10, v122
  v_dot2_f32_bf16 v123, v97, v116, v123
  v_dot2_f32_bf16 v124, v98, v10, v124
  v_dot2_f32_bf16 v125, v98, v116, v125
  v_dot2_f32_bf16 v126, v99, v10, v126
  v_dot2_f32_bf16 v127, v99, v116, v127
  s_waitcnt vmcnt(16)
  v_lshlrev_b32 v117, 16, v11
  v_dot2_f32_bf16 v120, v100, v11, v120
  v_dot2_f32_bf16 v121, v100, v117, v121
  v_dot2_f32_bf16 v122, v101, v11, v122
  v_dot2_f32_bf16 v123, v101, v117, v123
  v_dot2_f32_bf16 v124, v102, v11, v124
  v_dot2_f32_bf16 v125, v102, v117, v125
  v_dot2_f32_bf16 v126, v103, v11, v126
  v_dot2_f32_bf16 v127, v103, v117, v127
  s_waitcnt vmcnt(15)
  v_lshlrev_b32 v116, 16, v12
  v_dot2_f32_bf16 v120, v104, v12, v120
  v_dot2_f32_bf16 v121, v104, v116, v121
  v_dot2_f32_bf16 v122, v105, v12, v122
  v_dot2_f32_bf16 v123, v105, v116, v123
  v_dot2_f32_bf16 v124, v106, v12, v124
  v_dot2_f32_bf16 v125, v106, v116, v125
  v_dot2_f32_bf16 v126, v107, v12, v126
  v_dot2_f32_bf16 v127, v107, v116, v127
  s_waitcnt vmcnt(5)
  ds_read_b128 v[28:31], v6 offset:0
  ds_read_b128 v[32:35], v6 offset:1024
  ds_read_b128 v[36:39], v6 offset:2048
  ds_read_b128 v[40:43], v6 offset:3072
  ds_read_b128 v[44:47], v6 offset:4096
  ds_read_b128 v[48:51], v6 offset:5120
  ds_read_b128 v[52:55], v6 offset:6144
  ds_read_b128 v[56:59], v6 offset:7168
  s_waitcnt vmcnt(14)
  v_lshlrev_b32 v117, 16, v13
  v_dot2_f32_bf16 v120, v108, v13, v120
  v_dot2_f32_bf16 v121, v108, v117, v121
  v_dot2_f32_bf16 v122, v109, v13, v122
  v_dot2_f32_bf16 v123, v109, v117, v123
  v_dot2_f32_bf16 v124, v110, v13, v124
  v_dot2_f32_bf16 v125, v110, v117, v125
  v_dot2_f32_bf16 v126, v111, v13, v126
  v_dot2_f32_bf16 v127, v111, v117, v127
  s_waitcnt vmcnt(13)
  v_lshlrev_b32 v116, 16, v14
  v_dot2_f32_bf16 v120, v112, v14, v120
  v_dot2_f32_bf16 v121, v112, v116, v121
  v_dot2_f32_bf16 v122, v113, v14, v122
  v_dot2_f32_bf16 v123, v113, v116, v123
  v_dot2_f32_bf16 v124, v114, v14, v124
  v_dot2_f32_bf16 v125, v114, v116, v125
  v_dot2_f32_bf16 v126, v115, v14, v126
  v_dot2_f32_bf16 v127, v115, v116, v127
  s_waitcnt lgkmcnt(0)
  v_lshlrev_b32 v117, 16, v15
  v_dot2_f32_bf16 v120, v28, v15, v120
  v_dot2_f32_bf16 v121, v28, v117, v121
  v_dot2_f32_bf16 v122, v29, v15, v122
  v_dot2_f32_bf16 v123, v29, v117, v123
  v_dot2_f32_bf16 v124, v30, v15, v124
  v_dot2_f32_bf16 v125, v30, v117, v125
  v_dot2_f32_bf16 v126, v31, v15, v126
  v_dot2_f32_bf16 v127, v31, v117, v127
  v_lshlrev_b32 v116, 16, v16
  v_dot2_f32_bf16 v120, v32, v16, v120
  v_dot2_f32_bf16 v121, v32, v116, v121
  v_dot2_f32_bf16 v122, v33, v16, v122
  v_dot2_f32_bf16 v123, v33, v116, v123
  v_dot2_f32_bf16 v124, v34, v16, v124
  v_dot2_f32_bf16 v125, v34, v116, v125
  v_dot2_f32_bf16 v126, v35, v16, v126
  v_dot2_f32_bf16 v127, v35, v116, v127
  v_lshlrev_b32 v117, 16, v17
  v_dot2_f32_bf16 v120, v36, v17, v120
  v_dot2_f32_bf16 v121, v36, v117, v121
  v_dot2_f32_bf16 v122, v37, v17, v122
  v_dot2_f32_bf16 v123, v37, v117, v123
  v_dot2_f32_bf16 v124, v38, v17, v124
  v_dot2_f32_bf16 v125, v38, v117, v125
  v_dot2_f32_bf16 v126, v39, v17, v126
  v_dot2_f32_bf16 v127, v39, v117, v127
  v_lshlrev_b32 v116, 16, v18
  v_dot2_f32_bf16 v120, v40, v18, v120
  v_dot2_f32_bf16 v121, v40, v116, v121
  v_dot2_f32_bf16 v122, v41, v18, v122
  v_dot2_f32_bf16 v123, v41, v116, v123
  v_dot2_f32_bf16 v124, v42, v18, v124
  v_dot2_f32_bf16 v125, v42, v116, v125
  v_dot2_f32_bf16 v126, v43, v18, v126
  v_dot2_f32_bf16 v127, v43, v116, v127
  v_lshlrev_b32 v117, 16, v19
  v_dot2_f32_bf16 v120, v44, v19, v120
  v_dot2_f32_bf16 v121, v44, v117, v121
  v_dot2_f32_bf16 v122, v45, v19, v122
  v_dot2_f32_bf16 v123, v45, v117, v123
  v_dot2_f32_bf16 v124, v46, v19, v124
  v_dot2_f32_bf16 v125, v46, v117, v125
  v_dot2_f32_bf16 v126, v47, v19, v126
  v_dot2_f32_bf16 v127, v47, v117, v127
  v_lshlrev_b32 v116, 16, v20
  v_dot2_f32_bf16 v120, v48, v20, v120
  v_dot2_f32_bf16 v121, v48, v116, v121
  v_dot2_f32_bf16 v122, v49, v20, v122
  v_dot2_f32_bf16 v123, v49, v116, v123
  v_dot2_f32_bf16 v124, v50, v20, v124
  v_dot2_f32_bf16 v125, v50, v116, v125
  v_dot2_f32_bf16 v126, v51, v20, v126
  v_dot2_f32_bf16 v127, v51, v116, v127
  v_lshlrev_b32 v117, 16, v21
  v_dot2_f32_bf16 v120, v52, v21, v120
  v_dot2_f32_bf16 v121, v52, v117, v121
  v_dot2_f32_bf16 v122, v53, v21, v122
  v_dot2_f32_bf16 v123, v53, v117, v123
  v_dot2_f32_bf16 v124, v54, v21, v124
  v_dot2_f32_bf16 v125, v54, v117, v125
  v_dot2_f32_bf16 v126, v55, v21, v126
  v_dot2_f32_bf16 v127, v55, v117, v127
  v_lshlrev_b32 v116, 16, v22
  v_dot2_f32_bf16 v120, v56, v22, v120
  v_dot2_f32_bf16 v121, v56, v116, v121
  v_dot2_f32_bf16 v122, v57, v22, v122
  v_dot2_f32_bf16 v123, v57, v116, v123
  v_dot2_f32_bf16 v124, v58, v22, v124
  v_dot2_f32_bf16 v125, v58, v116, v125
  v_dot2_f32_bf16 v126, v59, v22, v126
  v_dot2_f32_bf16 v127, v59, v116, v127
  s_waitcnt vmcnt(4)
  v_lshlrev_b32 v117, 16, v23
  v_dot2_f32_bf16 v120, v60, v23, v120
  v_dot2_f32_bf16 v121, v60, v117, v121
  v_dot2_f32_bf16 v122, v61, v23, v122
  v_dot2_f32_bf16 v123, v61, v117, v123
  v_dot2_f32_bf16 v124, v62, v23, v124
  v_dot2_f32_bf16 v125, v62, v117, v125
  v_dot2_f32_bf16 v126, v63, v23, v126
  v_dot2_f32_bf16 v127, v63, v117, v127
  s_waitcnt vmcnt(3)
  v_lshlrev_b32 v116, 16, v24
  v_dot2_f32_bf16 v120, v64, v24, v120
  v_dot2_f32_bf16 v121, v64, v116, v121
  v_dot2_f32_bf16 v122, v65, v24, v122
  v_dot2_f32_bf16 v123, v65, v116, v123
  v_dot2_f32_bf16 v124, v66, v24, v124
  v_dot2_f32_bf16 v125, v66, v116, v125
  v_dot2_f32_bf16 v126, v67, v24, v126
  v_dot2_f32_bf16 v127, v67, v116, v127
  s_waitcnt vmcnt(2)
  v_lshlrev_b32 v117, 16, v25
  v_dot2_f32_bf16 v120, v68, v25, v120
  v_dot2_f32_bf16 v121, v68, v117, v121
  v_dot2_f32_bf16 v122, v69, v25, v122
  v_dot2_f32_bf16 v123, v69, v117, v123
  v_dot2_f32_bf16 v124, v70, v25, v124
  v_dot2_f32_bf16 v125, v70, v117, v125
  v_dot2_f32_bf16 v126, v71, v25, v126
  v_dot2_f32_bf16 v127, v71, v117, v127
  s_waitcnt vmcnt(1)
  v_lshlrev_b32 v116, 16, v26
  v_dot2_f32_bf16 v120, v72, v26, v120
  v_dot2_f32_bf16 v121, v72, v116, v121
  v_dot2_f32_bf16 v122, v73, v26, v122
  v_dot2_f32_bf16 v123, v73, v116, v123
  v_dot2_f32_bf16 v124, v74, v26, v124
  v_dot2_f32_bf16 v125, v74, v116, v125
  v_dot2_f32_bf16 v126, v75, v26, v126
  v_dot2_f32_bf16 v127, v75, v116, v127
  s_waitcnt vmcnt(0)
  v_lshlrev_b32 v117, 16, v27
  v_dot2_f32_bf16 v120, v76, v27, v120
  v_dot2_f32_bf16 v121, v76, v117, v121
  v_dot2_f32_bf16 v122, v77, v27, v122
  v_dot2_f32_bf16 v123, v77, v117, v123
  v_dot2_f32_bf16 v124, v78, v27, v124
  v_dot2_f32_bf16 v125, v78, v117, v125
  v_dot2_f32_bf16 v126, v79, v27, v126
  v_dot2_f32_bf16 v127, v79, v117, v127
  v_lshrrev_b32 v6, 5, v2
  s_lshl_b32 s7, s3, 1
  v_add_u32 v6, s7, v6
  v_lshlrev_b32 v7, 10, v6
  v_and_b32 v3, 31, v2
  v_lshlrev_b32 v8, 5, v3
  v_add_u32 v7, v7, v8
  ds_write_b128 v7, v[120:123] offset:1024
  ds_write_b128 v7, v[124:127] offset:1040
  v_lshlrev_b32 v6, 3, v6
  v_cmp_eq_u32 vcc, 0, v3
  s_nop 0
  s_and_saveexec_b64 s[8:9], vcc
  ds_write_b64 v6, v[4:5] offset:32768
  s_mov_b64 exec, s[8:9]
  s_waitcnt lgkmcnt(0)
  s_nop 4
L_b2:
  s_barrier
  s_cmp_ge_u32 s3, 4
  s_cbranch_scc1 L_send
  v_mov_b32 v1, 0
  ds_read_b128 v[8:11], v1 offset:32768
  ds_read_b128 v[12:15], v1 offset:32784
  ds_read_b128 v[16:19], v1 offset:32800
  ds_read_b128 v[20:23], v1 offset:32816
  ds_read_b128 v[24:27], v1 offset:32832
  ds_read_b128 v[28:31], v1 offset:32848
  ds_read_b128 v[32:35], v1 offset:32864
  ds_read_b128 v[36:39], v1 offset:32880
  ds_read_b128 v[40:43], v1 offset:32896
  ds_read_b128 v[44:47], v1 offset:32912
  ds_read_b128 v[48:51], v1 offset:32928
  ds_read_b128 v[52:55], v1 offset:32944
  ds_read_b128 v[56:59], v1 offset:32960
  ds_read_b128 v[60:63], v1 offset:32976
  ds_read_b128 v[64:67], v1 offset:32992
  v_lshlrev_b32 v2, 2, v0
  ds_read_b32 v70, v2 offset:1024
  ds_read_b32 v71, v2 offset:2048
  ds_read_b32 v72, v2 offset:3072
  ds_read_b32 v73, v2 offset:4096
  ds_read_b32 v74, v2 offset:5120
  ds_read_b32 v75, v2 offset:6144
  ds_read_b32 v76, v2 offset:7168
  ds_read_b32 v77, v2 offset:8192
  ds_read_b32 v78, v2 offset:9216
  ds_read_b32 v79, v2 offset:10240
  ds_read_b32 v80, v2 offset:11264
  ds_read_b32 v81, v2 offset:12288
  ds_read_b32 v82, v2 offset:13312
  ds_read_b32 v83, v2 offset:14336
  ds_read_b32 v84, v2 offset:15360
  ds_read_b32 v85, v2 offset:16384
  ds_read_b32 v86, v2 offset:17408
  ds_read_b32 v87, v2 offset:18432
  ds_read_b32 v88, v2 offset:19456
  ds_read_b32 v89, v2 offset:20480
  ds_read_b32 v90, v2 offset:21504
  ds_read_b32 v91, v2 offset:22528
  ds_read_b32 v92, v2 offset:23552
  ds_read_b32 v93, v2 offset:24576
  ds_read_b32 v94, v2 offset:25600
  ds_read_b32 v95, v2 offset:26624
  ds_read_b32 v96, v2 offset:27648
  ds_read_b32 v97, v2 offset:28672
  ds_read_b32 v98, v2 offset:29696
  ds_read_b32 v99, v2 offset:30720
  s_waitcnt lgkmcnt(0)
  v_max3_f32 v4, v8, v10, v12
  v_max3_f32 v4, v4, v14, v16
  v_max3_f32 v4, v4, v18, v20
  v_max3_f32 v4, v4, v22, v24
  v_max3_f32 v4, v4, v26, v28
  v_max3_f32 v4, v4, v30, v32
  v_max3_f32 v4, v4, v34, v36
  v_max3_f32 v4, v4, v38, v40
  v_max3_f32 v4, v4, v42, v44
  v_max3_f32 v4, v4, v46, v48
  v_max3_f32 v4, v4, v50, v52
  v_max3_f32 v4, v4, v54, v56
  v_max3_f32 v4, v4, v58, v60
  v_max3_f32 v4, v4, v62, v64
  v_max_f32 v4, v4, v66
  v_sub_f32 v8, v8, v4
  v_sub_f32 v10, v10, v4
  v_sub_f32 v12, v12, v4
  v_sub_f32 v14, v14, v4
  v_sub_f32 v16, v16, v4
  v_sub_f32 v18, v18, v4
  v_sub_f32 v20, v20, v4
  v_sub_f32 v22, v22, v4
  v_sub_f32 v24, v24, v4
  v_sub_f32 v26, v26, v4
  v_sub_f32 v28, v28, v4
  v_sub_f32 v30, v30, v4
  v_sub_f32 v32, v32, v4
  v_sub_f32 v34, v34, v4
  v_sub_f32 v36, v36, v4
  v_sub_f32 v38, v38, v4
  v_sub_f32 v40, v40, v4
  v_sub_f32 v42, v42, v4
  v_sub_f32 v44, v44, v4
  v_sub_f32 v46, v46, v4
  v_sub_f32 v48, v48, v4
  v_sub_f32 v50, v50, v4
  v_sub_f32 v52, v52, v4
  v_sub_f32 v54, v54, v4
  v_sub_f32 v56, v56, v4
  v_sub_f32 v58, v58, v4
  v_sub_f32 v60, v60, v4
  v_sub_f32 v62, v62, v4
  v_sub_f32 v64, v64, v4
  v_sub_f32 v66, v66, v4
  v_exp_f32 v8, v8
  v_exp_f32 v10, v10
  v_exp_f32 v12, v12
  v_exp_f32 v14, v14
  v_exp_f32 v16, v16
  v_exp_f32 v18, v18
  v_exp_f32 v20, v20
  v_exp_f32 v22, v22
  v_exp_f32 v24, v24
  v_exp_f32 v26, v26
  v_exp_f32 v28, v28
  v_exp_f32 v30, v30
  v_exp_f32 v32, v32
  v_exp_f32 v34, v34
  v_exp_f32 v36, v36
  v_exp_f32 v38, v38
  v_exp_f32 v40, v40
  v_exp_f32 v42, v42
  v_exp_f32 v44, v44
  v_exp_f32 v46, v46
  v_exp_f32 v48, v48
  v_exp_f32 v50, v50
  v_exp_f32 v52, v52
  v_exp_f32 v54, v54
  v_exp_f32 v56, v56
  v_exp_f32 v58, v58
  v_exp_f32 v60, v60
  v_exp_f32 v62, v62
  v_exp_f32 v64, v64
  v_exp_f32 v66, v66
  v_mov_b32 v5, 0
  v_mov_b32 v6, 0
  v_fmac_f32 v5, v8, v9
  v_fmac_f32 v6, v8, v70
  v_fmac_f32 v5, v10, v11
  v_fmac_f32 v6, v10, v71
  v_fmac_f32 v5, v12, v13
  v_fmac_f32 v6, v12, v72
  v_fmac_f32 v5, v14, v15
  v_fmac_f32 v6, v14, v73
  v_fmac_f32 v5, v16, v17
  v_fmac_f32 v6, v16, v74
  v_fmac_f32 v5, v18, v19
  v_fmac_f32 v6, v18, v75
  v_fmac_f32 v5, v20, v21
  v_fmac_f32 v6, v20, v76
  v_fmac_f32 v5, v22, v23
  v_fmac_f32 v6, v22, v77
  v_fmac_f32 v5, v24, v25
  v_fmac_f32 v6, v24, v78
  v_fmac_f32 v5, v26, v27
  v_fmac_f32 v6, v26, v79
  v_fmac_f32 v5, v28, v29
  v_fmac_f32 v6, v28, v80
  v_fmac_f32 v5, v30, v31
  v_fmac_f32 v6, v30, v81
  v_fmac_f32 v5, v32, v33
  v_fmac_f32 v6, v32, v82
  v_fmac_f32 v5, v34, v35
  v_fmac_f32 v6, v34, v83
  v_fmac_f32 v5, v36, v37
  v_fmac_f32 v6, v36, v84
  v_fmac_f32 v5, v38, v39
  v_fmac_f32 v6, v38, v85
  v_fmac_f32 v5, v40, v41
  v_fmac_f32 v6, v40, v86
  v_fmac_f32 v5, v42, v43
  v_fmac_f32 v6, v42, v87
  v_fmac_f32 v5, v44, v45
  v_fmac_f32 v6, v44, v88
  v_fmac_f32 v5, v46, v47
  v_fmac_f32 v6, v46, v89
  v_fmac_f32 v5, v48, v49
  v_fmac_f32 v6, v48, v90
  v_fmac_f32 v5, v50, v51
  v_fmac_f32 v6, v50, v91
  v_fmac_f32 v5, v52, v53
  v_fmac_f32 v6, v52, v92
  v_fmac_f32 v5, v54, v55
  v_fmac_f32 v6, v54, v93
  v_fmac_f32 v5, v56, v57
  v_fmac_f32 v6, v56, v94
  v_fmac_f32 v5, v58, v59
  v_fmac_f32 v6, v58, v95
  v_fmac_f32 v5, v60, v61
  v_fmac_f32 v6, v60, v96
  v_fmac_f32 v5, v62, v63
  v_fmac_f32 v6, v62, v97
  v_fmac_f32 v5, v64, v65
  v_fmac_f32 v6, v64, v98
  v_fmac_f32 v5, v66, v67
  v_fmac_f32 v6, v66, v99
  v_min_u32 v4, s94, v4
  v_min_u32 v5, s94, v5
  v_min_u32 v6, s94, v6
  s_lshl_b32 s7, s4, 10
  v_add_u32 v2, s7, v2
  v_add_u32 v2, 65536, v2
  global_store_dword v2, v6, s[42:43] sc1
  s_lshl_b32 s7, s4, 3
  s_add_u32 s7, s7, 294912
  v_mov_b32 v3, s7
  v_cmp_eq_u32 vcc, 0, v0
  s_nop 0
  s_and_saveexec_b64 s[8:9], vcc
  global_store_dwordx2 v3, v[4:5], s[42:43] sc1
  s_mov_b64 exec, s[8:9]
  s_nop 4
L_send:
  s_endpgm
  s_nop 4
L_ctrl:
  s_setprio 3
  v_mov_b32 v3, 0
  ds_write_b32 v3, v3 offset:1020
  s_waitcnt lgkmcnt(0)
  s_barrier
  v_mov_b32 v3, 0
  s_mov_b32 s90, 0
  s_nop 4
L_ci_1:
  global_load_dword v4, v3, s[40:41] offset:8 sc1
  s_waitcnt vmcnt(0)
  v_readfirstlane_b32 s8, v4
  s_nop 0
  s_cmp_ge_u32 s8, 32
  s_cbranch_scc1 L_cid_2
  s_add_u32 s90, s90, 1
  s_cmp_ge_u32 s90, 200000
  s_cbranch_scc1 L_cid_2
  s_sleep 32
  s_branch L_ci_1
  s_nop 4
L_cid_2:
  s_lshl_b32 s7, s5, 9
  s_add_u32 s7, s7, 434176
  v_and_b32 v3, 31, v2
  v_lshlrev_b32 v3, 4, v3
  v_add_u32 v5, s7, v3
  s_mov_b32 s90, 0
  s_nop 4
L_cq_3:
  global_load_dwordx4 v[8:11], v5, s[42:43] sc1
  s_waitcnt vmcnt(0)
  v_max_u32 v12, v8, v9
  v_max3_u32 v12, v12, v10, v11
  v_cmp_eq_u32 vcc, -1, v12
  s_cbranch_vccz L_cqd_4
  s_add_u32 s90, s90, 1
  s_cmp_ge_u32 s90, 200000
  s_cbranch_scc1 L_cqd_4
  s_sleep 16
  s_branch L_cq_3
  s_nop 4
L_cqd_4:
  ds_write_b128 v3, v[8:11]
  s_waitcnt lgkmcnt(0)
  v_mov_b32 v3, 0
  v_mov_b32 v4, 1
  ds_write_b32 v3, v4 offset:1020
  s_waitcnt lgkmcnt(0)
  s_branch L_b2
  s_nop 4
L_service:
  s_mov_b32 s44, s36
  s_and_b32 s45, s37, 0xffff
  s_mov_b32 s46, 2408448
  s_mov_b32 s47, 0x20000
  s_mov_b32 s48, s22
  s_and_b32 s49, s23, 0xffff
  s_mov_b32 s50, 3670016
  s_mov_b32 s51, 0x20000
  s_mov_b32 s52, s34
  s_and_b32 s53, s35, 0xffff
  s_mov_b32 s54, 1792
  s_mov_b32 s55, 0x20000
  s_mov_b32 s56, s16
  s_and_b32 s57, s17, 0xffff
  s_mov_b32 s58, 1792
  s_mov_b32 s59, 0x20000
  v_lshrrev_b32 v29, 4, v2
  v_and_b32 v30, 15, v2
  v_mov_b32 v64, -1
  v_mov_b32 v65, -1
  v_mov_b32 v66, -1
  v_mov_b32 v67, -1
  s_mul_i32 s4, s2, 12288
  s_add_u32 s4, s4, 65536
  v_lshlrev_b32 v3, 4, v0
  v_add_u32 v3, s4, v3
  s_cmp_ge_u32 s3, 12
  s_cbranch_scc1 L_noinit_5
  global_store_dwordx4 v3, v[64:67], s[42:43] sc1
  s_nop 4
L_noinit_5:
  v_lshrrev_b32 v3, 2, v2
  s_lshl_b32 s4, s3, 5
  v_add_u32 v3, s4, v3
  v_mov_b32 v96, v3
  s_mov_b32 s5, 5376
  v_mul_lo_u32 v4, v3, s5
  v_and_b32 v5, 3, v2
  v_lshlrev_b32 v5, 4, v5
  s_lshl_b32 s6, s2, 6
  v_add3_u32 v4, v4, v5, s6
  s_mov_b32 s60, 86016
  buffer_load_dwordx4 v[100:103], v4, s[44:47], 0 offen
  buffer_load_dwordx4 v[104:107], v4, s[44:47], s60 offen
  v_lshlrev_b32 v6, 1, v0
  buffer_load_ushort v7, v6, s[52:55], 0 offen
  buffer_load_ushort v26, v6, s[56:59], 0 offen
  s_cmp_ge_u32 s3, 7
  s_cselect_b32 s7, 896, 0
  v_lshlrev_b32 v8, 4, v2
  v_add_u32 v8, s7, v8
  v_mov_b32 v9, 0x40000000
  v_cmp_gt_u32 vcc, 56, v2
  s_nop 1
  v_cndmask_b32 v8, v9, v8, vcc
  buffer_load_dwordx4 v[10:13], v8, s[56:59], 0 offen
  v_add_u32 v3, 64, v0
  v_cmp_gt_u32 vcc, 448, v0
  s_nop 1
  v_cndmask_b32 v31, v3, v0, vcc
  v_subrev_u32 v3, 896, v0
  v_and_b32 v4, 63, v3
  v_lshrrev_b32 v3, 6, v3
  v_lshlrev_b32 v3, 9, v3
  v_add_u32 v3, v3, v4
  v_add_u32 v3, 448, v3
  v_cmp_gt_u32 vcc, 896, v0
  s_nop 1
  v_cndmask_b32 v31, v3, v31, vcc
  v_add_u32 v3, 2240, v0
  v_cmp_gt_u32 vcc, 448, v0
  s_nop 1
  v_cndmask_b32 v27, v3, v0, vcc
  v_lshlrev_b32 v27, 2, v27
  v_mov_b32 v4, 0
  v_lshlrev_b32 v3, 2, v2
  v_cmp_gt_u32 vcc, 16, v2
  s_nop 0
  s_and_saveexec_b64 s[8:9], vcc
  ds_write_b32 v3, v4 offset:6144
  s_mov_b64 exec, s[8:9]
  s_waitcnt vmcnt(0)
  v_lshlrev_b32 v7, 16, v7
  v_lshlrev_b32 v26, 16, v26
  v_mul_f32 v8, 0xbfb8aa3b, v7
  v_exp_f32 v8, v8
  s_nop 0
  v_add_f32 v8, 1.0, v8
  v_rcp_f32 v8, v8
  s_nop 0
  v_mul_f32 v8, v7, v8
  v_cvt_pk_bf16_f32 v25, v8, 0
  v_lshlrev_b32 v3, 2, v31
  ds_write_b32 v3, v25 offset:0
  v_and_b32 v14, 0xffff0000, v10
  v_and_b32 v15, 0xffff0000, v11
  v_and_b32 v16, 0xffff0000, v12
  v_and_b32 v17, 0xffff0000, v13
  v_lshlrev_b32 v10, 16, v10
  v_lshlrev_b32 v11, 16, v11
  v_lshlrev_b32 v12, 16, v12
  v_lshlrev_b32 v13, 16, v13
  v_add_f32 v18, v10, v11
  v_add_f32 v18, v18, v12
  v_add_f32 v18, v18, v13
  v_add_f32 v18, v18, v14
  v_add_f32 v18, v18, v15
  v_add_f32 v18, v18, v16
  v_add_f32 v18, v18, v17
  s_nop 1
  v_add_f32_dpp v18, v18, v18 quad_perm:[1,0,3,2] row_mask:0xf bank_mask:0xf
  s_nop 1
  v_add_f32_dpp v18, v18, v18 quad_perm:[2,3,0,1] row_mask:0xf bank_mask:0xf
  s_nop 1
  v_add_f32_dpp v18, v18, v18 row_half_mirror row_mask:0xf bank_mask:0xf
  s_nop 1
  v_add_f32_dpp v18, v18, v18 row_mirror row_mask:0xf bank_mask:0xf
  v_mov_b32 v19, v18
  s_nop 1
  v_permlane16_swap_b32 v18, v19
  v_add_f32 v18, v18, v19
  v_mov_b32 v19, v18
  s_nop 1
  v_permlane32_swap_b32 v18, v19
  v_add_f32 v18, v18, v19
  v_mul_f32 v18, 0x3b124925, v18
  v_sub_f32 v19, v10, v18
  v_mul_f32 v20, v19, v19
  v_sub_f32 v19, v11, v18
  v_fmac_f32 v20, v19, v19
  v_sub_f32 v19, v12, v18
  v_fmac_f32 v20, v19, v19
  v_sub_f32 v19, v13, v18
  v_fmac_f32 v20, v19, v19
  v_sub_f32 v19, v14, v18
  v_fmac_f32 v20, v19, v19
  v_sub_f32 v19, v15, v18
  v_fmac_f32 v20, v19, v19
  v_sub_f32 v19, v16, v18
  v_fmac_f32 v20, v19, v19
  v_sub_f32 v19, v17, v18
  v_fmac_f32 v20, v19, v19
  v_cmp_gt_u32 vcc, 56, v2
  s_nop 1
  v_cndmask_b32 v20, 0, v20, vcc
  s_nop 1
  v_add_f32_dpp v20, v20, v20 quad_perm:[1,0,3,2] row_mask:0xf bank_mask:0xf
  s_nop 1
  v_add_f32_dpp v20, v20, v20 quad_perm:[2,3,0,1] row_mask:0xf bank_mask:0xf
  s_nop 1
  v_add_f32_dpp v20, v20, v20 row_half_mirror row_mask:0xf bank_mask:0xf
  s_nop 1
  v_add_f32_dpp v20, v20, v20 row_mirror row_mask:0xf bank_mask:0xf
  v_mov_b32 v19, v20
  s_nop 1
  v_permlane16_swap_b32 v20, v19
  v_add_f32 v20, v20, v19
  v_mov_b32 v19, v20
  s_nop 1
  v_permlane32_swap_b32 v20, v19
  v_add_f32 v20, v20, v19
  v_mul_f32 v20, 0x3b124925, v20
  v_cvt_pk_bf16_f32 v18, v18, v18
  v_lshlrev_b32 v18, 16, v18
  v_cvt_pk_bf16_f32 v20, v20, v20
  v_lshlrev_b32 v20, 16, v20
  v_add_f32 v20, 0x3727c5ac, v20
  v_cvt_pk_bf16_f32 v20, v20, v20
  v_lshlrev_b32 v20, 16, v20
  v_sqrt_f32 v20, v20
  s_nop 0
  v_cvt_pk_bf16_f32 v20, v20, v20
  v_lshlrev_b32 v20, 16, v20
  v_sub_f32 v24, v26, v18
  v_cvt_pk_bf16_f32 v24, v24, v24
  v_lshlrev_b32 v24, 16, v24
  v_rcp_f32 v21, v20
  s_nop 0
  v_mul_f32 v24, v24, v21
  v_cvt_pk_bf16_f32 v24, v24, v24
  v_lshlrev_b32 v24, 16, v24
  s_cmp_ge_u32 s3, 14
  s_cbranch_scc1 L_x_6
  v_lshlrev_b32 v3, 2, v0
  ds_write_b32 v3, v24 offset:6656
  s_nop 4
L_x_6:
  s_waitcnt lgkmcnt(0)
  s_barrier
  v_lshlrev_b32 v3, 2, v96
  ds_read_b32 v80, v3 offset:0
  ds_read_b32 v81, v3 offset:2048
  ds_read_b32 v82, v3 offset:64
  ds_read_b32 v83, v3 offset:2112
  v_mov_b32 v64, 0
  v_mov_b32 v65, 0
  v_mov_b32 v66, 0
  v_mov_b32 v67, 0
  v_mov_b32 v68, 0
  v_mov_b32 v69, 0
  v_mov_b32 v70, 0
  v_mov_b32 v71, 0
  v_mov_b32 v72, 0
  v_mov_b32 v73, 0
  v_mov_b32 v74, 0
  v_mov_b32 v75, 0
  v_mov_b32 v76, 0
  v_mov_b32 v77, 0
  v_mov_b32 v78, 0
  v_mov_b32 v79, 0
  s_waitcnt lgkmcnt(0)
  v_lshlrev_b32 v4, 16, v80
  v_lshlrev_b32 v5, 16, v81
  v_dot2_f32_bf16 v64, v100, v80, v64
  v_dot2_f32_bf16 v65, v100, v4, v65
  v_dot2_f32_bf16 v72, v100, v81, v72
  v_dot2_f32_bf16 v73, v100, v5, v73
  v_dot2_f32_bf16 v66, v101, v80, v66
  v_dot2_f32_bf16 v67, v101, v4, v67
  v_dot2_f32_bf16 v74, v101, v81, v74
  v_dot2_f32_bf16 v75, v101, v5, v75
  v_dot2_f32_bf16 v68, v102, v80, v68
  v_dot2_f32_bf16 v69, v102, v4, v69
  v_dot2_f32_bf16 v76, v102, v81, v76
  v_dot2_f32_bf16 v77, v102, v5, v77
  v_dot2_f32_bf16 v70, v103, v80, v70
  v_dot2_f32_bf16 v71, v103, v4, v71
  v_dot2_f32_bf16 v78, v103, v81, v78
  v_dot2_f32_bf16 v79, v103, v5, v79
  v_lshlrev_b32 v4, 16, v82
  v_lshlrev_b32 v5, 16, v83
  v_dot2_f32_bf16 v64, v104, v82, v64
  v_dot2_f32_bf16 v65, v104, v4, v65
  v_dot2_f32_bf16 v72, v104, v83, v72
  v_dot2_f32_bf16 v73, v104, v5, v73
  v_dot2_f32_bf16 v66, v105, v82, v66
  v_dot2_f32_bf16 v67, v105, v4, v67
  v_dot2_f32_bf16 v74, v105, v83, v74
  v_dot2_f32_bf16 v75, v105, v5, v75
  v_dot2_f32_bf16 v68, v106, v82, v68
  v_dot2_f32_bf16 v69, v106, v4, v69
  v_dot2_f32_bf16 v76, v106, v83, v76
  v_dot2_f32_bf16 v77, v106, v5, v77
  v_dot2_f32_bf16 v70, v107, v82, v70
  v_dot2_f32_bf16 v71, v107, v4, v71
  v_dot2_f32_bf16 v78, v107, v83, v78
  v_dot2_f32_bf16 v79, v107, v5, v79
  v_permlane32_swap_b32 v64, v72
  v_permlane32_swap_b32 v65, v73
  v_permlane32_swap_b32 v66, v74
  v_permlane32_swap_b32 v67, v75
  v_permlane32_swap_b32 v68, v76
  v_permlane32_swap_b32 v69, v77
  v_permlane32_swap_b32 v70, v78
  v_permlane32_swap_b32 v71, v79
  v_add_f32 v64, v64, v72
  v_add_f32 v65, v65, v73
  v_add_f32 v66, v66, v74
  v_add_f32 v67, v67, v75
  v_add_f32 v68, v68, v76
  v_add_f32 v69, v69, v77
  v_add_f32 v70, v70, v78
  v_add_f32 v71, v71, v79
  v_permlane16_swap_b32 v64, v68
  v_permlane16_swap_b32 v65, v69
  v_permlane16_swap_b32 v66, v70
  v_permlane16_swap_b32 v67, v71
  v_add_f32 v64, v64, v68
  v_add_f32 v65, v65, v69
  v_add_f32 v66, v66, v70
  v_add_f32 v67, v67, v71
  v_add_f32_dpp v64, v64, v64 row_ror:8 row_mask:0xf bank_mask:0x3
  v_add_f32_dpp v65, v65, v65 row_ror:8 row_mask:0xf bank_mask:0x3
  v_add_f32_dpp v64, v66, v66 row_ror:8 row_mask:0xf bank_mask:0xc
  v_add_f32_dpp v65, v67, v67 row_ror:8 row_mask:0xf bank_mask:0xc
  s_nop 0
  v_add_f32_dpp v64, v64, v64 row_shl:4 row_mask:0xf bank_mask:0x5
  v_add_f32_dpp v64, v65, v65 row_shr:4 row_mask:0xf bank_mask:0xa
  s_lshl_b32 s4, s3, 8
  v_lshlrev_b32 v3, 2, v2
  v_add_u32 v3, s4, v3
  ds_write_b32 v3, v64 offset:10752
  s_waitcnt lgkmcnt(0)
  s_barrier
  s_cmp_lg_u32 s3, 15
  s_cbranch_scc1 L_s1b_8
  s_setprio 3
  v_lshlrev_b32 v3, 2, v2
  ds_read_b32 v8, v3 offset:10752
  ds_read_b32 v9, v3 offset:11008
  ds_read_b32 v10, v3 offset:11264
  ds_read_b32 v11, v3 offset:11520
  ds_read_b32 v12, v3 offset:11776
  ds_read_b32 v13, v3 offset:12032
  ds_read_b32 v14, v3 offset:12288
  ds_read_b32 v15, v3 offset:12544
  ds_read_b32 v16, v3 offset:12800
  ds_read_b32 v17, v3 offset:13056
  ds_read_b32 v18, v3 offset:13312
  ds_read_b32 v19, v3 offset:13568
  ds_read_b32 v20, v3 offset:13824
  ds_read_b32 v21, v3 offset:14080
  ds_read_b32 v22, v3 offset:14336
  ds_read_b32 v23, v3 offset:14592
  s_waitcnt lgkmcnt(0)
  v_add_f32 v8, v8, v9
  v_add_f32 v8, v8, v10
  v_add_f32 v8, v8, v11
  v_add_f32 v8, v8, v12
  v_add_f32 v8, v8, v13
  v_add_f32 v8, v8, v14
  v_add_f32 v8, v8, v15
  v_add_f32 v8, v8, v16
  v_add_f32 v8, v8, v17
  v_add_f32 v8, v8, v18
  v_add_f32 v8, v8, v19
  v_add_f32 v8, v8, v20
  v_add_f32 v8, v8, v21
  v_add_f32 v8, v8, v22
  v_add_f32 v8, v8, v23
  v_cvt_pk_bf16_f32 v8, v8, v8
  v_lshlrev_b32 v8, 16, v8
  v_lshrrev_b32 v4, 5, v2
  s_mov_b32 s5, 2688
  v_mul_lo_u32 v4, v4, s5
  v_bfe_u32 v5, v2, 2, 3
  v_and_b32 v6, 3, v2
  v_lshlrev_b32 v6, 3, v6
  v_add3_u32 v4, v4, v5, v6
  s_lshl_b32 s5, s2, 5
  v_add_u32 v4, s5, v4
  v_lshlrev_b32 v4, 2, v4
  global_store_dword v4, v8, s[42:43] offset:0 sc1
  s_barrier
  s_waitcnt vmcnt(0)
  v_mov_b32 v4, 0
  v_mov_b32 v5, 1
  s_mov_b64 exec, 1
  global_atomic_add v4, v5, s[40:41] offset:8 sc1
  s_mov_b64 exec, -1
  v_mov_b32 v4, 0
  s_mov_b32 s90, 0
  s_nop 4
L_pa_9:
  global_load_dword v5, v4, s[40:41] offset:8 sc1
  s_waitcnt vmcnt(0)
  v_readfirstlane_b32 s8, v5
  s_nop 0
  s_cmp_ge_u32 s8, 32
  s_cbranch_scc1 L_pad_10
  s_add_u32 s90, s90, 1
  s_cmp_ge_u32 s90, 200000
  s_cbranch_scc1 L_pad_10
  s_sleep 1
  s_branch L_pa_9
  s_nop 4
L_pad_10:
  s_setprio 0
  s_branch L_s1_7
  s_nop 4
L_s1b_8:
  s_barrier
  v_lshlrev_b32 v3, 3, v29
  s_lshl_b32 s4, s3, 5
  v_add_u32 v3, s4, v3
  v_lshlrev_b32 v4, 13, v3
  v_lshlrev_b32 v5, 4, v30
  s_lshl_b32 s6, s2, 8
  v_add3_u32 v4, v4, v5, s6
  s_mov_b32 s61, 0
  buffer_load_dwordx4 v[32:35], v4, s[48:51], s61 offen
  s_mov_b32 s61, 8192
  buffer_load_dwordx4 v[36:39], v4, s[48:51], s61 offen
  s_mov_b32 s61, 16384
  buffer_load_dwordx4 v[40:43], v4, s[48:51], s61 offen
  s_mov_b32 s61, 24576
  buffer_load_dwordx4 v[44:47], v4, s[48:51], s61 offen
  s_mov_b32 s61, 32768
  buffer_load_dwordx4 v[48:51], v4, s[48:51], s61 offen
  s_mov_b32 s61, 40960
  buffer_load_dwordx4 v[52:55], v4, s[48:51], s61 offen
  s_mov_b32 s61, 49152
  buffer_load_dwordx4 v[56:59], v4, s[48:51], s61 offen
  s_mov_b32 s61, 57344
  buffer_load_dwordx4 v[60:63], v4, s[48:51], s61 offen
  s_nop 4
L_s1_7:
  s_waitcnt vmcnt(0)
  v_perm_b32 v64, v36, v32, s95
  v_perm_b32 v65, v44, v40, s95
  v_perm_b32 v66, v52, v48, s95
  v_perm_b32 v67, v60, v56, s95
  v_perm_b32 v68, v36, v32, s96
  v_perm_b32 v69, v44, v40, s96
  v_perm_b32 v70, v52, v48, s96
  v_perm_b32 v71, v60, v56, s96
  v_perm_b32 v72, v37, v33, s95
  v_perm_b32 v73, v45, v41, s95
  v_perm_b32 v74, v53, v49, s95
  v_perm_b32 v75, v61, v57, s95
  v_perm_b32 v76, v37, v33, s96
  v_perm_b32 v77, v45, v41, s96
  v_perm_b32 v78, v53, v49, s96
  v_perm_b32 v79, v61, v57, s96
  v_perm_b32 v80, v38, v34, s95
  v_perm_b32 v81, v46, v42, s95
  v_perm_b32 v82, v54, v50, s95
  v_perm_b32 v83, v62, v58, s95
  v_perm_b32 v84, v38, v34, s96
  v_perm_b32 v85, v46, v42, s96
  v_perm_b32 v86, v54, v50, s96
  v_perm_b32 v87, v62, v58, s96
  v_perm_b32 v88, v39, v35, s95
  v_perm_b32 v89, v47, v43, s95
  v_perm_b32 v90, v55, v51, s95
  v_perm_b32 v91, v63, v59, s95
  v_perm_b32 v92, v39, v35, s96
  v_perm_b32 v93, v47, v43, s96
  v_perm_b32 v94, v55, v51, s96
  v_perm_b32 v95, v63, v59, s96
  s_barrier
  s_cmp_ge_u32 s3, 14
  s_cbranch_scc1 L_s2_11
  global_load_dword v4, v27, s[42:43] offset:0 sc1
  global_load_dword v5, v27, s[42:43] offset:1792 sc1
  s_waitcnt vmcnt(0)
  v_add_f32 v5, 1.0, v5
  v_cvt_pk_bf16_f32 v5, v5, v5
  v_lshlrev_b32 v5, 16, v5
  v_mul_f32 v5, v24, v5
  v_cvt_pk_bf16_f32 v5, v5, v5
  v_lshlrev_b32 v5, 16, v5
  v_add_f32 v5, v5, v4
  v_cvt_pk_bf16_f32 v5, v5, v5
  v_lshlrev_b32 v3, 1, v31
  ds_write_b16 v3, v5 offset:4096
  s_waitcnt lgkmcnt(0)
  s_nop 4
L_s2_11:
  s_barrier
  s_cmp_ge_u32 s3, 14
  s_cbranch_scc1 L_s2b_12
  s_lshl_b32 s6, s3, 6
  v_mul_u32_u24 v4, 1024, v30
  v_lshlrev_b32 v5, 4, v29
  v_add3_u32 v4, v4, v5, s6
  v_add_u32 v4, 4096, v4
  v_mov_b32 v5, 6144
  v_cmp_gt_u32 vcc, 2, v30
  s_nop 1
  v_cndmask_b32 v4, v5, v4, vcc
  ds_read_b128 v[8:11], v4
  s_waitcnt lgkmcnt(0)
  v_mfma_f32_16x16x32_bf16 v[12:15], v[8:11], v[64:67], 0
  v_mfma_f32_16x16x32_bf16 v[64:67], v[8:11], v[68:71], 0
  v_mfma_f32_16x16x32_bf16 v[68:71], v[8:11], v[72:75], 0
  v_mfma_f32_16x16x32_bf16 v[72:75], v[8:11], v[76:79], 0
  v_mfma_f32_16x16x32_bf16 v[76:79], v[8:11], v[80:83], 0
  v_mfma_f32_16x16x32_bf16 v[80:83], v[8:11], v[84:87], 0
  v_mfma_f32_16x16x32_bf16 v[84:87], v[8:11], v[88:91], 0
  v_mfma_f32_16x16x32_bf16 v[88:91], v[8:11], v[92:95], 0
  s_lshl_b32 s6, s3, 10
  v_lshlrev_b32 v4, 6, v30
  v_add_u32 v4, s6, v4
  v_cmp_gt_u32 vcc, 16, v2
  s_nop 0
  s_and_saveexec_b64 s[8:9], vcc
  ds_write_b64 v4, v[12:13] offset:10752
  ds_write_b64 v4, v[64:65] offset:10760
  ds_write_b64 v4, v[68:69] offset:10768
  ds_write_b64 v4, v[72:73] offset:10776
  ds_write_b64 v4, v[76:77] offset:10784
  ds_write_b64 v4, v[80:81] offset:10792
  ds_write_b64 v4, v[84:85] offset:10800
  ds_write_b64 v4, v[88:89] offset:10808
  s_mov_b64 exec, s[8:9]
  s_waitcnt lgkmcnt(0)
  s_nop 4
L_s2b_12:
  s_barrier
  s_cmp_ge_u32 s3, 4
  s_cbranch_scc1 L_s3_13
  v_lshlrev_b32 v3, 2, v0
  ds_read_b32 v32, v3 offset:10752
  ds_read_b32 v33, v3 offset:11776
  ds_read_b32 v34, v3 offset:12800
  ds_read_b32 v35, v3 offset:13824
  ds_read_b32 v36, v3 offset:14848
  ds_read_b32 v37, v3 offset:15872
  ds_read_b32 v38, v3 offset:16896
  ds_read_b32 v39, v3 offset:17920
  ds_read_b32 v40, v3 offset:18944
  ds_read_b32 v41, v3 offset:19968
  ds_read_b32 v42, v3 offset:20992
  ds_read_b32 v43, v3 offset:22016
  ds_read_b32 v44, v3 offset:23040
  ds_read_b32 v45, v3 offset:24064
  s_waitcnt lgkmcnt(0)
  v_add_f32 v32, v32, v33
  v_add_f32 v32, v32, v34
  v_add_f32 v32, v32, v35
  v_add_f32 v32, v32, v36
  v_add_f32 v32, v32, v37
  v_add_f32 v32, v32, v38
  v_add_f32 v32, v32, v39
  v_add_f32 v32, v32, v40
  v_add_f32 v32, v32, v41
  v_add_f32 v32, v32, v42
  v_add_f32 v32, v32, v43
  v_add_f32 v32, v32, v44
  v_add_f32 v32, v32, v45
  s_nop 1
  v_mov_b32_dpp v33, v32 quad_perm:[2,3,2,3] row_mask:0xf bank_mask:0xf
  v_cvt_pk_bf16_f32 v32, v32, v33
  v_min_u32 v32, s94, v32
  v_and_b32 v4, 1, v0
  v_lshlrev_b32 v4, 13, v4
  v_lshrrev_b32 v5, 1, v0
  v_lshlrev_b32 v5, 1, v5
  s_lshl_b32 s6, s2, 8
  s_add_u32 s6, s6, 434176
  v_add3_u32 v4, v4, v5, s6
  v_and_b32 v5, 2, v0
  v_cmp_eq_u32 vcc, 0, v5
  s_nop 0
  s_and_saveexec_b64 s[8:9], vcc
  global_store_dword v4, v32, s[42:43] sc1
  s_mov_b64 exec, s[8:9]
  s_nop 4
L_s3_13:
  s_mov_b32 s52, s24
  s_and_b32 s53, s25, 0xffff
  s_mov_b32 s54, 3670016
  s_mov_b32 s55, 0x20000
  s_mov_b32 s56, s32
  s_and_b32 s57, s33, 0xffff
  s_mov_b32 s58, 1605632
  s_mov_b32 s59, 0x20000
  v_lshrrev_b32 v3, 3, v2
  s_lshl_b32 s4, s3, 5
  v_add_u32 v3, s4, v3
  v_mov_b32 v23, v3
  s_mov_b32 s5, 5376
  v_mul_lo_u32 v4, v3, s5
  v_and_b32 v5, 7, v2
  v_lshlrev_b32 v5, 4, v5
  s_lshl_b32 s6, s2, 7
  s_add_u32 s6, s6, 2048
  v_add3_u32 v4, v4, v5, s6
  v_mov_b32 v6, 0x40000000
  s_cmp_ge_u32 s2, 26
  s_cselect_b32 s6, 0x40000000, 0
  v_add_u32 v4, s6, v4
  s_mov_b32 s61, 0
  buffer_load_dwordx4 v[32:35], v4, s[44:47], s61 offen
  s_mov_b32 s61, 43008
  buffer_load_dwordx4 v[36:39], v4, s[44:47], s61 offen
  s_mov_b32 s61, 86016
  buffer_load_dwordx4 v[40:43], v4, s[44:47], s61 offen
  s_mov_b32 s61, 129024
  buffer_load_dwordx4 v[44:47], v4, s[44:47], s61 offen
  s_lshr_b32 s4, s2, 2
  s_and_b32 s5, s2, 3
  v_lshlrev_b32 v3, 3, v29
  s_lshl_b32 s6, s4, 9
  s_lshl_b32 s7, s3, 5
  s_add_u32 s6, s6, s7
  v_add_u32 v3, s6, v3
  s_movk_i32 s6, 896
  v_mul_lo_u32 v4, v3, s6
  v_lshlrev_b32 v6, 4, v30
  s_mul_i32 s6, s5, 224
  v_add3_u32 v4, v4, v6, s6
  v_mov_b32 v6, 0x40000000
  v_cmp_gt_u32 vcc, 14, v30
  s_nop 1
  v_cndmask_b32 v4, v6, v4, vcc
  s_mov_b32 s7, 3584
  buffer_load_dwordx4 v[96:99], v4, s[52:55], 0 offen offset:0
  buffer_load_dwordx4 v[100:103], v4, s[52:55], 0 offen offset:896
  buffer_load_dwordx4 v[104:107], v4, s[52:55], 0 offen offset:1792
  buffer_load_dwordx4 v[108:111], v4, s[52:55], 0 offen offset:2688
  buffer_load_dwordx4 v[112:115], v4, s[52:55], 0 offen offset:3584
  buffer_load_dwordx4 v[116:119], v4, s[52:55], s7 offen offset:896
  buffer_load_dwordx4 v[120:123], v4, s[52:55], s7 offen offset:1792
  buffer_load_dwordx4 v[124:127], v4, s[52:55], s7 offen offset:2688
  s_cmp_ge_u32 s2, 26
  s_cbranch_scc1 L_s4_14
  v_lshlrev_b32 v3, 2, v23
  ds_read_b32 v80, v3 offset:0
  ds_read_b32 v81, v3 offset:2048
  ds_read_b32 v82, v3 offset:32
  ds_read_b32 v83, v3 offset:2080
  ds_read_b32 v84, v3 offset:64
  ds_read_b32 v85, v3 offset:2112
  ds_read_b32 v86, v3 offset:96
  ds_read_b32 v87, v3 offset:2144
  v_mov_b32 v64, 0
  v_mov_b32 v65, 0
  v_mov_b32 v66, 0
  v_mov_b32 v67, 0
  v_mov_b32 v68, 0
  v_mov_b32 v69, 0
  v_mov_b32 v70, 0
  v_mov_b32 v71, 0
  v_mov_b32 v72, 0
  v_mov_b32 v73, 0
  v_mov_b32 v74, 0
  v_mov_b32 v75, 0
  v_mov_b32 v76, 0
  v_mov_b32 v77, 0
  v_mov_b32 v78, 0
  v_mov_b32 v79, 0
  s_waitcnt lgkmcnt(0)
  s_waitcnt vmcnt(8)
  v_lshlrev_b32 v4, 16, v80
  v_lshlrev_b32 v5, 16, v81
  v_dot2_f32_bf16 v64, v32, v80, v64
  v_dot2_f32_bf16 v65, v32, v4, v65
  v_dot2_f32_bf16 v72, v32, v81, v72
  v_dot2_f32_bf16 v73, v32, v5, v73
  v_dot2_f32_bf16 v66, v33, v80, v66
  v_dot2_f32_bf16 v67, v33, v4, v67
  v_dot2_f32_bf16 v74, v33, v81, v74
  v_dot2_f32_bf16 v75, v33, v5, v75
  v_dot2_f32_bf16 v68, v34, v80, v68
  v_dot2_f32_bf16 v69, v34, v4, v69
  v_dot2_f32_bf16 v76, v34, v81, v76
  v_dot2_f32_bf16 v77, v34, v5, v77
  v_dot2_f32_bf16 v70, v35, v80, v70
  v_dot2_f32_bf16 v71, v35, v4, v71
  v_dot2_f32_bf16 v78, v35, v81, v78
  v_dot2_f32_bf16 v79, v35, v5, v79
  v_lshlrev_b32 v4, 16, v82
  v_lshlrev_b32 v5, 16, v83
  v_dot2_f32_bf16 v64, v36, v82, v64
  v_dot2_f32_bf16 v65, v36, v4, v65
  v_dot2_f32_bf16 v72, v36, v83, v72
  v_dot2_f32_bf16 v73, v36, v5, v73
  v_dot2_f32_bf16 v66, v37, v82, v66
  v_dot2_f32_bf16 v67, v37, v4, v67
  v_dot2_f32_bf16 v74, v37, v83, v74
  v_dot2_f32_bf16 v75, v37, v5, v75
  v_dot2_f32_bf16 v68, v38, v82, v68
  v_dot2_f32_bf16 v69, v38, v4, v69
  v_dot2_f32_bf16 v76, v38, v83, v76
  v_dot2_f32_bf16 v77, v38, v5, v77
  v_dot2_f32_bf16 v70, v39, v82, v70
  v_dot2_f32_bf16 v71, v39, v4, v71
  v_dot2_f32_bf16 v78, v39, v83, v78
  v_dot2_f32_bf16 v79, v39, v5, v79
  v_lshlrev_b32 v4, 16, v84
  v_lshlrev_b32 v5, 16, v85
  v_dot2_f32_bf16 v64, v40, v84, v64
  v_dot2_f32_bf16 v65, v40, v4, v65
  v_dot2_f32_bf16 v72, v40, v85, v72
  v_dot2_f32_bf16 v73, v40, v5, v73
  v_dot2_f32_bf16 v66, v41, v84, v66
  v_dot2_f32_bf16 v67, v41, v4, v67
  v_dot2_f32_bf16 v74, v41, v85, v74
  v_dot2_f32_bf16 v75, v41, v5, v75
  v_dot2_f32_bf16 v68, v42, v84, v68
  v_dot2_f32_bf16 v69, v42, v4, v69
  v_dot2_f32_bf16 v76, v42, v85, v76
  v_dot2_f32_bf16 v77, v42, v5, v77
  v_dot2_f32_bf16 v70, v43, v84, v70
  v_dot2_f32_bf16 v71, v43, v4, v71
  v_dot2_f32_bf16 v78, v43, v85, v78
  v_dot2_f32_bf16 v79, v43, v5, v79
  v_lshlrev_b32 v4, 16, v86
  v_lshlrev_b32 v5, 16, v87
  v_dot2_f32_bf16 v64, v44, v86, v64
  v_dot2_f32_bf16 v65, v44, v4, v65
  v_dot2_f32_bf16 v72, v44, v87, v72
  v_dot2_f32_bf16 v73, v44, v5, v73
  v_dot2_f32_bf16 v66, v45, v86, v66
  v_dot2_f32_bf16 v67, v45, v4, v67
  v_dot2_f32_bf16 v74, v45, v87, v74
  v_dot2_f32_bf16 v75, v45, v5, v75
  v_dot2_f32_bf16 v68, v46, v86, v68
  v_dot2_f32_bf16 v69, v46, v4, v69
  v_dot2_f32_bf16 v76, v46, v87, v76
  v_dot2_f32_bf16 v77, v46, v5, v77
  v_dot2_f32_bf16 v70, v47, v86, v70
  v_dot2_f32_bf16 v71, v47, v4, v71
  v_dot2_f32_bf16 v78, v47, v87, v78
  v_dot2_f32_bf16 v79, v47, v5, v79
  v_permlane32_swap_b32 v64, v72
  v_permlane32_swap_b32 v65, v73
  v_permlane32_swap_b32 v66, v74
  v_permlane32_swap_b32 v67, v75
  v_permlane32_swap_b32 v68, v76
  v_permlane32_swap_b32 v69, v77
  v_permlane32_swap_b32 v70, v78
  v_permlane32_swap_b32 v71, v79
  v_add_f32 v64, v64, v72
  v_add_f32 v65, v65, v73
  v_add_f32 v66, v66, v74
  v_add_f32 v67, v67, v75
  v_add_f32 v68, v68, v76
  v_add_f32 v69, v69, v77
  v_add_f32 v70, v70, v78
  v_add_f32 v71, v71, v79
  v_permlane16_swap_b32 v64, v68
  v_permlane16_swap_b32 v65, v69
  v_permlane16_swap_b32 v66, v70
  v_permlane16_swap_b32 v67, v71
  v_add_f32 v64, v64, v68
  v_add_f32 v65, v65, v69
  v_add_f32 v66, v66, v70
  v_add_f32 v67, v67, v71
  v_add_f32_dpp v64, v64, v64 row_ror:8 row_mask:0xf bank_mask:0x3
  v_add_f32_dpp v65, v65, v65 row_ror:8 row_mask:0xf bank_mask:0x3
  v_add_f32_dpp v64, v66, v66 row_ror:8 row_mask:0xf bank_mask:0xc
  v_add_f32_dpp v65, v67, v67 row_ror:8 row_mask:0xf bank_mask:0xc
  s_lshl_b32 s6, s3, 9
  v_lshlrev_b32 v3, 3, v2
  v_add_u32 v3, s6, v3
  ds_write_b64 v3, v[64:65] offset:10752
  s_waitcnt lgkmcnt(0)
  s_barrier
  s_cmp_lg_u32 s3, 15
  s_cbranch_scc1 L_s5_15
  v_lshlrev_b32 v3, 3, v2
  ds_read_b64 v[32:33], v3 offset:10752
  ds_read_b64 v[34:35], v3 offset:11264
  ds_read_b64 v[36:37], v3 offset:11776
  ds_read_b64 v[38:39], v3 offset:12288
  ds_read_b64 v[40:41], v3 offset:12800
  ds_read_b64 v[42:43], v3 offset:13312
  ds_read_b64 v[44:45], v3 offset:13824
  ds_read_b64 v[46:47], v3 offset:14336
  ds_read_b64 v[48:49], v3 offset:14848
  ds_read_b64 v[50:51], v3 offset:15360
  ds_read_b64 v[52:53], v3 offset:15872
  ds_read_b64 v[54:55], v3 offset:16384
  ds_read_b64 v[56:57], v3 offset:16896
  ds_read_b64 v[58:59], v3 offset:17408
  ds_read_b64 v[60:61], v3 offset:17920
  ds_read_b64 v[62:63], v3 offset:18432
  s_waitcnt lgkmcnt(0)
  v_add_f32 v32, v32, v34
  v_add_f32 v33, v33, v35
  v_add_f32 v32, v32, v36
  v_add_f32 v33, v33, v37
  v_add_f32 v32, v32, v38
  v_add_f32 v33, v33, v39
  v_add_f32 v32, v32, v40
  v_add_f32 v33, v33, v41
  v_add_f32 v32, v32, v42
  v_add_f32 v33, v33, v43
  v_add_f32 v32, v32, v44
  v_add_f32 v33, v33, v45
  v_add_f32 v32, v32, v46
  v_add_f32 v33, v33, v47
  v_add_f32 v32, v32, v48
  v_add_f32 v33, v33, v49
  v_add_f32 v32, v32, v50
  v_add_f32 v33, v33, v51
  v_add_f32 v32, v32, v52
  v_add_f32 v33, v33, v53
  v_add_f32 v32, v32, v54
  v_add_f32 v33, v33, v55
  v_add_f32 v32, v32, v56
  v_add_f32 v33, v33, v57
  v_add_f32 v32, v32, v58
  v_add_f32 v33, v33, v59
  v_add_f32 v32, v32, v60
  v_add_f32 v33, v33, v61
  v_add_f32 v32, v32, v62
  v_add_f32 v33, v33, v63
  v_cvt_pk_bf16_f32 v32, v32, v32
  v_lshlrev_b32 v32, 16, v32
  v_cvt_pk_bf16_f32 v33, v33, v33
  v_lshlrev_b32 v33, 16, v33
  v_lshrrev_b32 v4, 5, v2
  s_mov_b32 s6, 2688
  v_mul_lo_u32 v4, v4, s6
  v_bfe_u32 v5, v2, 3, 2
  v_lshlrev_b32 v5, 1, v5
  v_and_b32 v6, 7, v2
  v_lshlrev_b32 v6, 3, v6
  v_add3_u32 v4, v4, v5, v6
  s_lshl_b32 s6, s2, 6
  s_add_u32 s6, s6, 1024
  v_add_u32 v4, s6, v4
  v_lshlrev_b32 v4, 2, v4
  global_store_dwordx2 v4, v[32:33], s[42:43] offset:0 sc1
  s_waitcnt vmcnt(0)
  v_mov_b32 v4, 0
  v_mov_b32 v5, 1
  s_mov_b64 exec, 1
  global_atomic_add v4, v5, s[40:41] offset:4 sc1
  s_mov_b64 exec, -1
  s_nop 4
L_s5_15:
  s_nop 4
L_s4_14:
  v_lshlrev_b32 v3, 3, v29
  s_lshl_b32 s6, s3, 5
  v_add_u32 v3, s6, v3
  s_movk_i32 s6, 3584
  v_mul_lo_u32 v4, v3, s6
  v_and_b32 v5, 7, v30
  v_lshlrev_b32 v5, 4, v5
  s_lshl_b32 s6, s2, 7
  v_add3_u32 v4, v4, v5, s6
  v_cmp_gt_u32 vcc, 8, v30
  v_mov_b32 v5, s30
  v_mov_b32 v6, s28
  v_cndmask_b32 v8, v5, v6, vcc
  v_mov_b32 v5, s31
  v_mov_b32 v6, s29
  v_cndmask_b32 v9, v5, v6, vcc
  v_add_co_u32 v8, vcc, v8, v4
  s_nop 1
  v_addc_co_u32 v9, vcc, 0, v9, vcc
  s_mov_b32 s14, 0
  s_cmp_ge_u32 s2, 28
  s_cbranch_scc1 L_nogu_16
  s_cmp_ge_u32 s3, 14
  s_cbranch_scc1 L_nogu_16
  s_mov_b32 s14, 1
  s_waitcnt vmcnt(0)
  global_load_dwordx4 v[64:67], v[8:9], off
  v_add_co_u32 v8, vcc, 3584, v8
  s_nop 1
  v_addc_co_u32 v9, vcc, 0, v9, vcc
  global_load_dwordx4 v[68:71], v[8:9], off
  v_add_co_u32 v8, vcc, 3584, v8
  s_nop 1
  v_addc_co_u32 v9, vcc, 0, v9, vcc
  global_load_dwordx4 v[72:75], v[8:9], off
  v_add_co_u32 v8, vcc, 3584, v8
  s_nop 1
  v_addc_co_u32 v9, vcc, 0, v9, vcc
  global_load_dwordx4 v[76:79], v[8:9], off
  v_add_co_u32 v8, vcc, 3584, v8
  s_nop 1
  v_addc_co_u32 v9, vcc, 0, v9, vcc
  global_load_dwordx4 v[80:83], v[8:9], off
  v_add_co_u32 v8, vcc, 3584, v8
  s_nop 1
  v_addc_co_u32 v9, vcc, 0, v9, vcc
  global_load_dwordx4 v[84:87], v[8:9], off
  v_add_co_u32 v8, vcc, 3584, v8
  s_nop 1
  v_addc_co_u32 v9, vcc, 0, v9, vcc
  global_load_dwordx4 v[88:91], v[8:9], off
  v_add_co_u32 v8, vcc, 3584, v8
  s_nop 1
  v_addc_co_u32 v9, vcc, 0, v9, vcc
  global_load_dwordx4 v[92:95], v[8:9], off
  s_nop 4
L_nogu_16:
  s_cmp_eq_u32 s14, 1
  s_cbranch_scc1 L_w_17
  s_waitcnt vmcnt(0)
  s_nop 4
L_w_17:
  v_perm_b32 v32, v100, v96, s95
  v_perm_b32 v33, v108, v104, s95
  v_perm_b32 v34, v116, v112, s95
  v_perm_b32 v35, v124, v120, s95
  v_perm_b32 v36, v100, v96, s96
  v_perm_b32 v37, v108, v104, s96
  v_perm_b32 v38, v116, v112, s96
  v_perm_b32 v39, v124, v120, s96
  v_perm_b32 v40, v101, v97, s95
  v_perm_b32 v41, v109, v105, s95
  v_perm_b32 v42, v117, v113, s95
  v_perm_b32 v43, v125, v121, s95
  v_perm_b32 v44, v101, v97, s96
  v_perm_b32 v45, v109, v105, s96
  v_perm_b32 v46, v117, v113, s96
  v_perm_b32 v47, v125, v121, s96
  v_perm_b32 v48, v102, v98, s95
  v_perm_b32 v49, v110, v106, s95
  v_perm_b32 v50, v118, v114, s95
  v_perm_b32 v51, v126, v122, s95
  v_perm_b32 v52, v102, v98, s96
  v_perm_b32 v53, v110, v106, s96
  v_perm_b32 v54, v118, v114, s96
  v_perm_b32 v55, v126, v122, s96
  v_perm_b32 v56, v103, v99, s95
  v_perm_b32 v57, v111, v107, s95
  v_perm_b32 v58, v119, v115, s95
  v_perm_b32 v59, v127, v123, s95
  v_perm_b32 v60, v103, v99, s96
  v_perm_b32 v61, v111, v107, s96
  v_perm_b32 v62, v119, v115, s96
  v_perm_b32 v63, v127, v123, s96
  s_waitcnt vmcnt(0)
  s_cmp_eq_u32 s14, 1
  s_cbranch_scc0 L_w2_18
  v_perm_b32 v96, v68, v64, s95
  v_perm_b32 v97, v76, v72, s95
  v_perm_b32 v98, v84, v80, s95
  v_perm_b32 v99, v92, v88, s95
  v_perm_b32 v100, v68, v64, s96
  v_perm_b32 v101, v76, v72, s96
  v_perm_b32 v102, v84, v80, s96
  v_perm_b32 v103, v92, v88, s96
  v_perm_b32 v104, v69, v65, s95
  v_perm_b32 v105, v77, v73, s95
  v_perm_b32 v106, v85, v81, s95
  v_perm_b32 v107, v93, v89, s95
  v_perm_b32 v108, v69, v65, s96
  v_perm_b32 v109, v77, v73, s96
  v_perm_b32 v110, v85, v81, s96
  v_perm_b32 v111, v93, v89, s96
  v_perm_b32 v112, v70, v66, s95
  v_perm_b32 v113, v78, v74, s95
  v_perm_b32 v114, v86, v82, s95
  v_perm_b32 v115, v94, v90, s95
  v_perm_b32 v116, v70, v66, s96
  v_perm_b32 v117, v78, v74, s96
  v_perm_b32 v118, v86, v82, s96
  v_perm_b32 v119, v94, v90, s96
  v_perm_b32 v120, v71, v67, s95
  v_perm_b32 v121, v79, v75, s95
  v_perm_b32 v122, v87, v83, s95
  v_perm_b32 v123, v95, v91, s95
  v_perm_b32 v124, v71, v67, s96
  v_perm_b32 v125, v79, v75, s96
  v_perm_b32 v126, v87, v83, s96
  v_perm_b32 v127, v95, v91, s96
  s_nop 4
L_w2_18:
  s_and_b32 s6, s3, 1
  s_lshl_b32 s6, s6, 5
  s_lshl_b32 s7, s2, 6
  s_add_u32 s6, s6, s7
  v_lshlrev_b32 v3, 3, v29
  v_add_u32 v3, s6, v3
  s_movk_i32 s6, 896
  v_mul_lo_u32 v4, v3, s6
  s_lshr_b32 s6, s3, 1
  s_lshl_b32 s6, s6, 8
  v_lshlrev_b32 v5, 4, v30
  v_add_u32 v5, s6, v5
  v_add_u32 v4, v4, v5
  v_mov_b32 v6, 0x40000000
  v_cmp_gt_u32 vcc, 896, v5
  s_nop 1
  v_cndmask_b32 v4, v6, v4, vcc
  s_mov_b32 s7, 3584
  buffer_load_dwordx4 v[64:67], v4, s[56:59], 0 offen offset:0
  buffer_load_dwordx4 v[68:71], v4, s[56:59], 0 offen offset:896
  buffer_load_dwordx4 v[72:75], v4, s[56:59], 0 offen offset:1792
  buffer_load_dwordx4 v[76:79], v4, s[56:59], 0 offen offset:2688
  buffer_load_dwordx4 v[80:83], v4, s[56:59], 0 offen offset:3584
  buffer_load_dwordx4 v[84:87], v4, s[56:59], s7 offen offset:896
  buffer_load_dwordx4 v[88:91], v4, s[56:59], s7 offen offset:1792
  buffer_load_dwordx4 v[92:95], v4, s[56:59], s7 offen offset:2688
  s_cmp_lg_u32 s3, 0
  s_cbranch_scc1 L_t1_19
  v_mov_b32 v4, 0
  s_mov_b32 s90, 0
  s_nop 4
L_pq_20:
  global_load_dword v5, v4, s[40:41] offset:8 sc1
  s_waitcnt vmcnt(0)
  v_readfirstlane_b32 s8, v5
  s_nop 0
  s_cmp_ge_u32 s8, 32
  s_cbranch_scc1 L_pqd_21
  s_add_u32 s90, s90, 1
  s_cmp_ge_u32 s90, 200000
  s_cbranch_scc1 L_pqd_21
  s_sleep 1
  s_branch L_pq_20
  s_nop 4
L_pqd_21:
  v_cmp_le_u32 vcc, 14, v2
  v_mov_b32 v5, 0
  v_mov_b32 v6, 98
  v_cndmask_b32 v5, v5, v6, vcc
  v_add_u32 v5, v5, v2
  s_mul_i32 s6, s4, 14
  v_add_u32 v5, s6, v5
  v_lshlrev_b32 v5, 3, v5
  v_add_u32 v5, 294912, v5
  v_cmp_gt_u32 vcc, 28, v2
  s_nop 0
  s_and_saveexec_b64 s[10:11], vcc
  s_mov_b32 s90, 0
  s_nop 4
L_pml_22:
  global_load_dwordx2 v[6:7], v5, s[42:43] sc1
  s_waitcnt vmcnt(0)
  v_max_u32 v8, v6, v7
  v_cmp_eq_u32 vcc, -1, v8
  s_nop 1
  s_cmp_lg_u64 vcc, exec
  s_cbranch_scc1 L_pmld_23
  s_add_u32 s90, s90, 1
  s_cmp_ge_u32 s90, 200000
  s_cbranch_scc1 L_pmld_23
  s_sleep 1
  s_branch L_pml_22
  s_nop 4
L_pmld_23:
  s_mov_b64 exec, s[10:11]
  s_nop 4
L_t1_19:
  s_barrier
  s_lshr_b32 s6, s3, 3
  s_lshl_b32 s6, s6, 4
  s_lshr_b32 s7, s3, 2
  s_and_b32 s7, s7, 1
  s_add_u32 s6, s6, s7
  s_lshl_b32 s7, s4, 1
  s_add_u32 s6, s6, s7
  s_mul_i32 s6, s6, 7
  s_lshl_b32 s7, s6, 10
  s_add_u32 s7, s7, 65536
  v_and_b32 v3, 255, v0
  v_lshlrev_b32 v3, 2, v3
  v_add_u32 v3, s7, v3
  s_add_u32 s12, s42, 4096
  s_addc_u32 s13, s43, 0
  s_lshl_b32 s7, s6, 3
  s_add_u32 s7, s7, 294912
  v_mov_b32 v4, s7
  s_mov_b32 s90, 0
  s_nop 4
L_po_24:
  global_load_dword v5, v3, s[42:43] offset:0 sc1
  global_load_dword v6, v3, s[42:43] offset:1024 sc1
  global_load_dword v7, v3, s[42:43] offset:2048 sc1
  global_load_dword v8, v3, s[42:43] offset:3072 sc1
  global_load_dword v9, v3, s[12:13] offset:0 sc1
  global_load_dword v10, v3, s[12:13] offset:1024 sc1
  global_load_dword v11, v3, s[12:13] offset:2048 sc1
  global_load_dwordx4 v[12:15], v4, s[42:43] sc1
  global_load_dwordx4 v[16:19], v4, s[42:43] offset:16 sc1
  global_load_dwordx4 v[20:23], v4, s[42:43] offset:32 sc1
  global_load_dwordx2 v[24:25], v4, s[42:43] offset:48 sc1
  s_waitcnt vmcnt(0)
  v_max_u32 v1, v5, v6
  v_max3_u32 v1, v1, v7, v8
  v_max3_u32 v1, v1, v9, v10
  v_max3_u32 v1, v1, v11, v12
  v_max3_u32 v1, v1, v13, v14
  v_max3_u32 v1, v1, v15, v16
  v_max3_u32 v1, v1, v17, v18
  v_max3_u32 v1, v1, v19, v20
  v_max3_u32 v1, v1, v21, v22
  v_max3_u32 v1, v1, v23, v24
  v_max_u32 v1, v1, v25
  v_cmp_eq_u32 vcc, -1, v1
  s_cbranch_vccz L_pod_25
  s_add_u32 s90, s90, 1
  s_cmp_ge_u32 s90, 200000
  s_cbranch_scc1 L_pod_25
  s_branch L_po_24
  s_nop 4
L_pod_25:
  v_max3_f32 v1, v12, v14, v16
  v_max3_f32 v1, v1, v18, v20
  v_max3_f32 v1, v1, v22, v24
  v_sub_f32 v12, v12, v1
  v_sub_f32 v14, v14, v1
  v_sub_f32 v16, v16, v1
  v_sub_f32 v18, v18, v1
  v_sub_f32 v20, v20, v1
  v_sub_f32 v22, v22, v1
  v_sub_f32 v24, v24, v1
  v_exp_f32 v12, v12
  v_exp_f32 v14, v14
  v_exp_f32 v16, v16
  v_exp_f32 v18, v18
  v_exp_f32 v20, v20
  v_exp_f32 v22, v22
  v_exp_f32 v24, v24
  v_mul_f32 v1, v12, v13
  v_fmac_f32 v1, v14, v15
  v_fmac_f32 v1, v16, v17
  v_fmac_f32 v1, v18, v19
  v_fmac_f32 v1, v20, v21
  v_fmac_f32 v1, v22, v23
  v_fmac_f32 v1, v24, v25
  v_mul_f32 v4, v12, v5
  v_fmac_f32 v4, v14, v6
  v_fmac_f32 v4, v16, v7
  v_fmac_f32 v4, v18, v8
  v_fmac_f32 v4, v20, v9
  v_fmac_f32 v4, v22, v10
  v_fmac_f32 v4, v24, v11
  v_rcp_f32 v1, v1
  s_nop 0
  v_mul_f32 v8, v4, v1
  v_cvt_pk_bf16_f32 v8, v8, v8
  v_lshlrev_b32 v3, 1, v0
  ds_write_b16 v3, v8 offset:4096
  s_waitcnt lgkmcnt(0)
  s_barrier
  s_lshl_b32 s6, s3, 6
  v_mul_u32_u24 v4, 1024, v30
  v_lshlrev_b32 v5, 4, v29
  v_add3_u32 v4, v4, v5, s6
  v_add_u32 v4, 4096, v4
  v_mov_b32 v5, 6144
  v_cmp_gt_u32 vcc, 2, v30
  s_nop 1
  v_cndmask_b32 v4, v5, v4, vcc
  ds_read_b128 v[8:11], v4
  s_waitcnt lgkmcnt(0)
  v_mfma_f32_16x16x32_bf16 v[12:15], v[8:11], v[32:35], 0
  v_mfma_f32_16x16x32_bf16 v[32:35], v[8:11], v[36:39], 0
  v_mfma_f32_16x16x32_bf16 v[36:39], v[8:11], v[40:43], 0
  v_mfma_f32_16x16x32_bf16 v[40:43], v[8:11], v[44:47], 0
  v_mfma_f32_16x16x32_bf16 v[44:47], v[8:11], v[48:51], 0
  v_mfma_f32_16x16x32_bf16 v[48:51], v[8:11], v[52:55], 0
  v_mfma_f32_16x16x32_bf16 v[52:55], v[8:11], v[56:59], 0
  v_mfma_f32_16x16x32_bf16 v[56:59], v[8:11], v[60:63], 0
  s_lshl_b32 s6, s3, 10
  v_lshlrev_b32 v4, 6, v30
  v_add_u32 v4, s6, v4
  v_cmp_gt_u32 vcc, 16, v2
  s_nop 0
  s_and_saveexec_b64 s[8:9], vcc
  ds_write_b64 v4, v[12:13] offset:10752
  ds_write_b64 v4, v[32:33] offset:10760
  ds_write_b64 v4, v[36:37] offset:10768
  ds_write_b64 v4, v[40:41] offset:10776
  ds_write_b64 v4, v[44:45] offset:10784
  ds_write_b64 v4, v[48:49] offset:10792
  ds_write_b64 v4, v[52:53] offset:10800
  ds_write_b64 v4, v[56:57] offset:10808
  s_mov_b64 exec, s[8:9]
  s_waitcnt lgkmcnt(0)
  s_barrier
  s_cmp_ge_u32 s3, 4
  s_cbranch_scc1 L_t2_26
  v_lshlrev_b32 v3, 2, v0
  ds_read_b32 v32, v3 offset:10752
  ds_read_b32 v33, v3 offset:11776
  ds_read_b32 v34, v3 offset:12800
  ds_read_b32 v35, v3 offset:13824
  ds_read_b32 v36, v3 offset:14848
  ds_read_b32 v37, v3 offset:15872
  ds_read_b32 v38, v3 offset:16896
  ds_read_b32 v39, v3 offset:17920
  ds_read_b32 v40, v3 offset:18944
  ds_read_b32 v41, v3 offset:19968
  ds_read_b32 v42, v3 offset:20992
  ds_read_b32 v43, v3 offset:22016
  ds_read_b32 v44, v3 offset:23040
  ds_read_b32 v45, v3 offset:24064
  ds_read_b32 v46, v3 offset:25088
  ds_read_b32 v47, v3 offset:26112
  s_waitcnt lgkmcnt(0)
  v_add_f32 v32, v32, v33
  v_add_f32 v32, v32, v34
  v_add_f32 v32, v32, v35
  v_add_f32 v32, v32, v36
  v_add_f32 v32, v32, v37
  v_add_f32 v32, v32, v38
  v_add_f32 v32, v32, v39
  v_add_f32 v32, v32, v40
  v_add_f32 v32, v32, v41
  v_add_f32 v32, v32, v42
  v_add_f32 v32, v32, v43
  v_add_f32 v32, v32, v44
  v_add_f32 v32, v32, v45
  v_add_f32 v32, v32, v46
  v_add_f32 v32, v32, v47
  v_min_u32 v32, s94, v32
  v_and_b32 v4, 1, v0
  v_mul_u32_u24 v4, 448, v4
  v_lshrrev_b32 v5, 1, v0
  s_mul_i32 s6, s4, 896
  s_mul_i32 s7, s5, 112
  s_add_u32 s6, s6, s7
  v_add3_u32 v4, v4, v5, s6
  v_lshlrev_b32 v4, 2, v4
  v_add_u32 v4, 299008, v4
  v_cmp_gt_u32 vcc, 112, v5
  s_nop 0
  s_and_saveexec_b64 s[8:9], vcc
  global_store_dword v4, v32, s[42:43] sc1
  s_mov_b64 exec, s[8:9]
  s_nop 4
L_t2_26:
  s_cmp_ge_u32 s2, 28
  s_cbranch_scc1 L_end
  s_cmp_lg_u32 s3, 15
  s_cbranch_scc1 L_t3_27
  v_mov_b32 v4, 0
  s_mov_b32 s90, 0
  s_nop 4
L_pa2_28:
  global_load_dword v5, v4, s[40:41] offset:4 sc1
  s_waitcnt vmcnt(0)
  v_readfirstlane_b32 s8, v5
  s_nop 0
  s_cmp_ge_u32 s8, 26
  s_cbranch_scc1 L_pa2d_29
  s_add_u32 s90, s90, 1
  s_cmp_ge_u32 s90, 200000
  s_cbranch_scc1 L_pa2d_29
  s_sleep 1
  s_branch L_pa2_28
  s_nop 4
L_pa2d_29:
  s_nop 4
L_t3_27:
  s_barrier
  s_cmp_ge_u32 s3, 14
  s_cbranch_scc1 L_t4_30
  global_load_dword v16, v27, s[42:43] offset:3584 sc1
  v_add_u32 v4, 5376, v27
  global_load_dword v17, v4, s[42:43] offset:0 sc1
  global_load_dword v18, v4, s[42:43] offset:1792 sc1
  v_lshlrev_b32 v3, 2, v0
  v_add_u32 v3, 299008, v3
  v_add_u32 v4, 3584, v3
  v_add_u32 v5, 7168, v4
  v_add_u32 v6, 7168, v5
  v_add_u32 v7, 7168, v6
  s_mov_b32 s90, 0
  s_nop 4
L_y_31:
  global_load_dword v8, v3, s[42:43] sc1
  global_load_dword v9, v4, s[42:43] sc1
  global_load_dword v10, v4, s[42:43] offset:3584 sc1
  global_load_dword v11, v5, s[42:43] sc1
  global_load_dword v12, v5, s[42:43] offset:3584 sc1
  global_load_dword v13, v6, s[42:43] sc1
  global_load_dword v14, v6, s[42:43] offset:3584 sc1
  global_load_dword v15, v7, s[42:43] sc1
  s_waitcnt vmcnt(0)
  v_max_u32 v19, v8, v9
  v_max3_u32 v19, v19, v10, v11
  v_max3_u32 v19, v19, v12, v13
  v_max3_u32 v19, v19, v14, v15
  v_cmp_eq_u32 vcc, -1, v19
  s_cbranch_vccz L_yd_32
  s_add_u32 s90, s90, 1
  s_cmp_ge_u32 s90, 200000
  s_cbranch_scc1 L_yd_32
  s_branch L_y_31
  s_nop 4
L_yd_32:
  v_add_f32 v8, v8, v9
  v_add_f32 v8, v8, v10
  v_add_f32 v8, v8, v11
  v_add_f32 v8, v8, v12
  v_add_f32 v8, v8, v13
  v_add_f32 v8, v8, v14
  v_add_f32 v8, v8, v15
  v_cvt_pk_bf16_f32 v8, v8, v8
  v_lshlrev_b32 v8, 16, v8
  v_mul_f32 v8, v16, v8
  v_cvt_pk_bf16_f32 v8, v8, v8
  v_lshlrev_b32 v8, 16, v8
  v_add_f32 v28, v26, v8
  v_cvt_pk_bf16_f32 v28, v28, v28
  v_lshlrev_b32 v28, 16, v28
  v_lshlrev_b32 v3, 2, v0
  ds_write_b32 v3, v28 offset:6656
  s_waitcnt lgkmcnt(0)
  s_nop 4
L_t4_30:
  s_barrier
  s_cmp_ge_u32 s3, 14
  s_cbranch_scc1 L_t5_33
  s_cmp_ge_u32 s3, 7
  s_cselect_b32 s7, 1792, 0
  v_lshlrev_b32 v3, 2, v2
  v_add_u32 v3, s7, v3
  ds_read_b32 v8, v3 offset:6656
  ds_read_b32 v9, v3 offset:6912
  ds_read_b32 v10, v3 offset:7168
  ds_read_b32 v11, v3 offset:7424
  ds_read_b32 v12, v3 offset:7680
  ds_read_b32 v13, v3 offset:7936
  ds_read_b32 v14, v3 offset:8192
  s_waitcnt lgkmcnt(0)
  v_add_f32 v4, v8, v9
  v_add_f32 v4, v4, v10
  v_add_f32 v4, v4, v11
  v_add_f32 v4, v4, v12
  v_add_f32 v4, v4, v13
  v_add_f32 v4, v4, v14
  s_nop 1
  v_add_f32_dpp v4, v4, v4 quad_perm:[1,0,3,2] row_mask:0xf bank_mask:0xf
  s_nop 1
  v_add_f32_dpp v4, v4, v4 quad_perm:[2,3,0,1] row_mask:0xf bank_mask:0xf
  s_nop 1
  v_add_f32_dpp v4, v4, v4 row_half_mirror row_mask:0xf bank_mask:0xf
  s_nop 1
  v_add_f32_dpp v4, v4, v4 row_mirror row_mask:0xf bank_mask:0xf
  v_mov_b32 v5, v4
  s_nop 1
  v_permlane16_swap_b32 v4, v5
  v_add_f32 v4, v4, v5
  v_mov_b32 v5, v4
  s_nop 1
  v_permlane32_swap_b32 v4, v5
  v_add_f32 v4, v4, v5
  v_mul_f32 v4, 0x3b124925, v4
  v_sub_f32 v5, v8, v4
  v_mul_f32 v6, v5, v5
  v_sub_f32 v5, v9, v4
  v_fmac_f32 v6, v5, v5
  v_sub_f32 v5, v10, v4
  v_fmac_f32 v6, v5, v5
  v_sub_f32 v5, v11, v4
  v_fmac_f32 v6, v5, v5
  v_sub_f32 v5, v12, v4
  v_fmac_f32 v6, v5, v5
  v_sub_f32 v5, v13, v4
  v_fmac_f32 v6, v5, v5
  v_sub_f32 v5, v14, v4
  v_fmac_f32 v6, v5, v5
  s_nop 1
  v_add_f32_dpp v6, v6, v6 quad_perm:[1,0,3,2] row_mask:0xf bank_mask:0xf
  s_nop 1
  v_add_f32_dpp v6, v6, v6 quad_perm:[2,3,0,1] row_mask:0xf bank_mask:0xf
  s_nop 1
  v_add_f32_dpp v6, v6, v6 row_half_mirror row_mask:0xf bank_mask:0xf
  s_nop 1
  v_add_f32_dpp v6, v6, v6 row_mirror row_mask:0xf bank_mask:0xf
  v_mov_b32 v5, v6
  s_nop 1
  v_permlane16_swap_b32 v6, v5
  v_add_f32 v6, v6, v5
  v_mov_b32 v5, v6
  s_nop 1
  v_permlane32_swap_b32 v6, v5
  v_add_f32 v6, v6, v5
  v_mul_f32 v6, 0x3b124925, v6
  v_cvt_pk_bf16_f32 v4, v4, v4
  v_lshlrev_b32 v4, 16, v4
  v_cvt_pk_bf16_f32 v6, v6, v6
  v_lshlrev_b32 v6, 16, v6
  v_add_f32 v6, 0x3727c5ac, v6
  v_cvt_pk_bf16_f32 v6, v6, v6
  v_lshlrev_b32 v6, 16, v6
  v_sqrt_f32 v6, v6
  s_nop 0
  v_cvt_pk_bf16_f32 v6, v6, v6
  v_lshlrev_b32 v6, 16, v6
  v_sub_f32 v15, v28, v4
  v_cvt_pk_bf16_f32 v15, v15, v15
  v_lshlrev_b32 v15, 16, v15
  v_rcp_f32 v16, v6
  s_nop 0
  v_mul_f32 v15, v15, v16
  v_cvt_pk_bf16_f32 v15, v15, v15
  v_lshlrev_b32 v15, 16, v15
  v_add_f32 v18, 1.0, v18
  v_cvt_pk_bf16_f32 v18, v18, v18
  v_lshlrev_b32 v18, 16, v18
  v_mul_f32 v18, v15, v18
  v_cvt_pk_bf16_f32 v18, v18, v18
  v_lshlrev_b32 v18, 16, v18
  v_add_f32 v18, v18, v17
  v_cvt_pk_bf16_f32 v18, v18, v18
  v_lshlrev_b32 v3, 1, v31
  ds_write_b16 v3, v18 offset:4096
  s_waitcnt lgkmcnt(0)
  s_nop 4
L_t5_33:
  s_barrier
  s_cmp_ge_u32 s3, 14
  s_cbranch_scc1 L_t5b_34
  s_lshl_b32 s6, s3, 6
  v_mul_u32_u24 v4, 1024, v30
  v_lshlrev_b32 v5, 4, v29
  v_add3_u32 v4, v4, v5, s6
  v_add_u32 v4, 4096, v4
  v_mov_b32 v5, 6144
  v_cmp_gt_u32 vcc, 2, v30
  s_nop 1
  v_cndmask_b32 v4, v5, v4, vcc
  ds_read_b128 v[8:11], v4
  s_waitcnt lgkmcnt(0)
  v_mfma_f32_16x16x32_bf16 v[12:15], v[8:11], v[96:99], 0
  v_mfma_f32_16x16x32_bf16 v[96:99], v[8:11], v[100:103], 0
  v_mfma_f32_16x16x32_bf16 v[100:103], v[8:11], v[104:107], 0
  v_mfma_f32_16x16x32_bf16 v[104:107], v[8:11], v[108:111], 0
  v_mfma_f32_16x16x32_bf16 v[108:111], v[8:11], v[112:115], 0
  v_mfma_f32_16x16x32_bf16 v[112:115], v[8:11], v[116:119], 0
  v_mfma_f32_16x16x32_bf16 v[116:119], v[8:11], v[120:123], 0
  v_mfma_f32_16x16x32_bf16 v[120:123], v[8:11], v[124:127], 0
  s_lshl_b32 s6, s3, 10
  v_lshlrev_b32 v4, 6, v30
  v_add_u32 v4, s6, v4
  v_cmp_gt_u32 vcc, 16, v2
  s_nop 0
  s_and_saveexec_b64 s[8:9], vcc
  ds_write_b64 v4, v[12:13] offset:10752
  ds_write_b64 v4, v[96:97] offset:10760
  ds_write_b64 v4, v[100:101] offset:10768
  ds_write_b64 v4, v[104:105] offset:10776
  ds_write_b64 v4, v[108:109] offset:10784
  ds_write_b64 v4, v[112:113] offset:10792
  ds_write_b64 v4, v[116:117] offset:10800
  ds_write_b64 v4, v[120:121] offset:10808
  s_mov_b64 exec, s[8:9]
  s_waitcnt lgkmcnt(0)
  s_nop 4
L_t5b_34:
  s_barrier
  s_cmp_ge_u32 s3, 2
  s_cbranch_scc1 L_t6_35
  v_lshlrev_b32 v3, 2, v0
  ds_read_b32 v32, v3 offset:10752
  ds_read_b32 v48, v3 offset:11264
  ds_read_b32 v33, v3 offset:11776
  ds_read_b32 v49, v3 offset:12288
  ds_read_b32 v34, v3 offset:12800
  ds_read_b32 v50, v3 offset:13312
  ds_read_b32 v35, v3 offset:13824
  ds_read_b32 v51, v3 offset:14336
  ds_read_b32 v36, v3 offset:14848
  ds_read_b32 v52, v3 offset:15360
  ds_read_b32 v37, v3 offset:15872
  ds_read_b32 v53, v3 offset:16384
  ds_read_b32 v38, v3 offset:16896
  ds_read_b32 v54, v3 offset:17408
  ds_read_b32 v39, v3 offset:17920
  ds_read_b32 v55, v3 offset:18432
  ds_read_b32 v40, v3 offset:18944
  ds_read_b32 v56, v3 offset:19456
  ds_read_b32 v41, v3 offset:19968
  ds_read_b32 v57, v3 offset:20480
  ds_read_b32 v42, v3 offset:20992
  ds_read_b32 v58, v3 offset:21504
  ds_read_b32 v43, v3 offset:22016
  ds_read_b32 v59, v3 offset:22528
  ds_read_b32 v44, v3 offset:23040
  ds_read_b32 v60, v3 offset:23552
  ds_read_b32 v45, v3 offset:24064
  ds_read_b32 v61, v3 offset:24576
  s_waitcnt lgkmcnt(0)
  v_add_f32 v32, v32, v33
  v_add_f32 v48, v48, v49
  v_add_f32 v32, v32, v34
  v_add_f32 v48, v48, v50
  v_add_f32 v32, v32, v35
  v_add_f32 v48, v48, v51
  v_add_f32 v32, v32, v36
  v_add_f32 v48, v48, v52
  v_add_f32 v32, v32, v37
  v_add_f32 v48, v48, v53
  v_add_f32 v32, v32, v38
  v_add_f32 v48, v48, v54
  v_add_f32 v32, v32, v39
  v_add_f32 v48, v48, v55
  v_add_f32 v32, v32, v40
  v_add_f32 v48, v48, v56
  v_add_f32 v32, v32, v41
  v_add_f32 v48, v48, v57
  v_add_f32 v32, v32, v42
  v_add_f32 v48, v48, v58
  v_add_f32 v32, v32, v43
  v_add_f32 v48, v48, v59
  v_add_f32 v32, v32, v44
  v_add_f32 v48, v48, v60
  v_add_f32 v32, v32, v45
  v_add_f32 v48, v48, v61
  v_cvt_pk_bf16_f32 v32, v32, v32
  v_lshlrev_b32 v32, 16, v32
  v_cvt_pk_bf16_f32 v48, v48, v48
  v_lshlrev_b32 v48, 16, v48
  v_mul_f32 v4, v32, v32
  v_mov_b32 v5, 0x3d372713
  v_fma_f32 v4, v4, v5, 1.0
  v_mul_f32 v4, v4, v32
  v_mul_f32 v4, 0x40135761, v4
  v_exp_f32 v4, v4
  s_nop 0
  v_add_f32 v4, 1.0, v4
  v_rcp_f32 v4, v4
  s_nop 0
  v_fma_f32 v4, v4, -2.0, 1.0
  v_add_f32 v4, 1.0, v4
  v_mul_f32 v4, v4, v32
  v_mul_f32 v4, 0.5, v4
  v_cvt_pk_bf16_f32 v4, v4, v4
  v_lshlrev_b32 v4, 16, v4
  v_mul_f32 v4, v4, v48
  v_cvt_pk_bf16_f32 v4, v4, v4
  v_and_b32 v5, 1, v0
  v_lshlrev_b32 v5, 7, v5
  v_and_b32 v6, 0xfe, v0
  v_add_u32 v5, v5, v6
  ds_write_b16 v5, v4 offset:10240
  s_waitcnt lgkmcnt(0)
  s_nop 4
L_t6_35:
  v_perm_b32 v32, v68, v64, s95
  v_perm_b32 v33, v76, v72, s95
  v_perm_b32 v34, v84, v80, s95
  v_perm_b32 v35, v92, v88, s95
  v_perm_b32 v36, v68, v64, s96
  v_perm_b32 v37, v76, v72, s96
  v_perm_b32 v38, v84, v80, s96
  v_perm_b32 v39, v92, v88, s96
  v_perm_b32 v40, v69, v65, s95
  v_perm_b32 v41, v77, v73, s95
  v_perm_b32 v42, v85, v81, s95
  v_perm_b32 v43, v93, v89, s95
  v_perm_b32 v44, v69, v65, s96
  v_perm_b32 v45, v77, v73, s96
  v_perm_b32 v46, v85, v81, s96
  v_perm_b32 v47, v93, v89, s96
  v_perm_b32 v48, v70, v66, s95
  v_perm_b32 v49, v78, v74, s95
  v_perm_b32 v50, v86, v82, s95
  v_perm_b32 v51, v94, v90, s95
  v_perm_b32 v52, v70, v66, s96
  v_perm_b32 v53, v78, v74, s96
  v_perm_b32 v54, v86, v82, s96
  v_perm_b32 v55, v94, v90, s96
  v_perm_b32 v56, v71, v67, s95
  v_perm_b32 v57, v79, v75, s95
  v_perm_b32 v58, v87, v83, s95
  v_perm_b32 v59, v95, v91, s95
  v_perm_b32 v60, v71, v67, s96
  v_perm_b32 v61, v79, v75, s96
  v_perm_b32 v62, v87, v83, s96
  v_perm_b32 v63, v95, v91, s96
  s_barrier
  s_cmp_ge_u32 s3, 8
  s_cbranch_scc1 L_t6b_36
  s_and_b32 s6, s3, 1
  s_lshl_b32 s6, s6, 6
  v_mul_u32_u24 v4, 128, v30
  v_lshlrev_b32 v5, 4, v29
  v_add3_u32 v4, v4, v5, s6
  v_add_u32 v4, 10240, v4
  v_mov_b32 v5, 6144
  v_cmp_gt_u32 vcc, 2, v30
  s_nop 1
  v_cndmask_b32 v4, v5, v4, vcc
  ds_read_b128 v[8:11], v4
  s_waitcnt lgkmcnt(0)
  v_mfma_f32_16x16x32_bf16 v[12:15], v[8:11], v[32:35], 0
  v_mfma_f32_16x16x32_bf16 v[32:35], v[8:11], v[36:39], 0
  v_mfma_f32_16x16x32_bf16 v[36:39], v[8:11], v[40:43], 0
  v_mfma_f32_16x16x32_bf16 v[40:43], v[8:11], v[44:47], 0
  v_mfma_f32_16x16x32_bf16 v[44:47], v[8:11], v[48:51], 0
  v_mfma_f32_16x16x32_bf16 v[48:51], v[8:11], v[52:55], 0
  v_mfma_f32_16x16x32_bf16 v[52:55], v[8:11], v[56:59], 0
  v_mfma_f32_16x16x32_bf16 v[56:59], v[8:11], v[60:63], 0
  s_lshl_b32 s6, s3, 10
  v_lshlrev_b32 v4, 6, v30
  v_add_u32 v4, s6, v4
  v_cmp_gt_u32 vcc, 16, v2
  s_nop 0
  s_and_saveexec_b64 s[8:9], vcc
  ds_write_b64 v4, v[12:13] offset:10752
  ds_write_b64 v4, v[32:33] offset:10760
  ds_write_b64 v4, v[36:37] offset:10768
  ds_write_b64 v4, v[40:41] offset:10776
  ds_write_b64 v4, v[44:45] offset:10784
  ds_write_b64 v4, v[48:49] offset:10792
  ds_write_b64 v4, v[52:53] offset:10800
  ds_write_b64 v4, v[56:57] offset:10808
  s_mov_b64 exec, s[8:9]
  s_waitcnt lgkmcnt(0)
  s_nop 4
L_t6b_36:
  s_barrier
  v_lshrrev_b32 v4, 8, v0
  v_lshlrev_b32 v4, 11, v4
  v_and_b32 v5, 255, v0
  v_lshlrev_b32 v6, 2, v5
  v_add_u32 v4, v4, v6
  ds_read_b32 v8, v4 offset:10752
  ds_read_b32 v9, v4 offset:11776
  v_lshrrev_b32 v4, 8, v0
  v_lshlrev_b32 v4, 7, v4
  v_lshrrev_b32 v5, 1, v5
  v_add_u32 v4, v4, v5
  v_and_b32 v5, 1, v0
  v_mul_u32_u24 v5, 448, v5
  v_add_u32 v5, v5, v4
  s_mul_i32 s6, s2, 896
  v_add_u32 v5, s6, v5
  v_lshlrev_b32 v5, 2, v5
  v_add_u32 v5, 327680, v5
  s_waitcnt lgkmcnt(0)
  v_add_f32 v8, v8, v9
  v_min_u32 v8, s94, v8
  v_cmp_gt_u32 vcc, 448, v4
  s_nop 0
  s_and_saveexec_b64 s[8:9], vcc
  global_store_dword v5, v8, s[42:43] sc1
  s_mov_b64 exec, s[8:9]
  s_cmp_lg_u32 s3, 0
  s_cbranch_scc1 L_end
  v_and_b32 v4, 1, v29
  v_mul_u32_u24 v4, 448, v4
  s_lshl_b32 s6, s2, 4
  v_add3_u32 v4, v4, v30, s6
  v_lshlrev_b32 v5, 2, v4
  v_add_u32 v6, 327680, v5
  v_and_b32 v7, 1, v29
  v_mul_u32_u24 v7, 2240, v7
  s_movk_i32 s6, 2240
  v_add3_u32 v7, v7, v4, s6
  v_lshlrev_b32 v7, 2, v7
  global_load_dword v92, v7, s[42:43] offset:0 sc1
  ds_read_b32 v93, v5 offset:6656
  s_mov_b32 s90, 0
  s_nop 4
L_z_37:
  v_mov_b32 v7, v6
  global_load_dword v32, v7, s[42:43] sc1
  v_add_u32 v7, 3584, v7
  global_load_dword v33, v7, s[42:43] sc1
  v_add_u32 v7, 3584, v7
  global_load_dword v34, v7, s[42:43] sc1
  v_add_u32 v7, 3584, v7
  global_load_dword v35, v7, s[42:43] sc1
  v_add_u32 v7, 3584, v7
  global_load_dword v36, v7, s[42:43] sc1
  v_add_u32 v7, 3584, v7
  global_load_dword v37, v7, s[42:43] sc1
  v_add_u32 v7, 3584, v7
  global_load_dword v38, v7, s[42:43] sc1
  v_add_u32 v7, 3584, v7
  global_load_dword v39, v7, s[42:43] sc1
  v_add_u32 v7, 3584, v7
  global_load_dword v40, v7, s[42:43] sc1
  v_add_u32 v7, 3584, v7
  global_load_dword v41, v7, s[42:43] sc1
  v_add_u32 v7, 3584, v7
  global_load_dword v42, v7, s[42:43] sc1
  v_add_u32 v7, 3584, v7
  global_load_dword v43, v7, s[42:43] sc1
  v_add_u32 v7, 3584, v7
  global_load_dword v44, v7, s[42:43] sc1
  v_add_u32 v7, 3584, v7
  global_load_dword v45, v7, s[42:43] sc1
  v_add_u32 v7, 3584, v7
  global_load_dword v46, v7, s[42:43] sc1
  v_add_u32 v7, 3584, v7
  global_load_dword v47, v7, s[42:43] sc1
  v_add_u32 v7, 3584, v7
  global_load_dword v48, v7, s[42:43] sc1
  v_add_u32 v7, 3584, v7
  global_load_dword v49, v7, s[42:43] sc1
  v_add_u32 v7, 3584, v7
  global_load_dword v50, v7, s[42:43] sc1
  v_add_u32 v7, 3584, v7
  global_load_dword v51, v7, s[42:43] sc1
  v_add_u32 v7, 3584, v7
  global_load_dword v52, v7, s[42:43] sc1
  v_add_u32 v7, 3584, v7
  global_load_dword v53, v7, s[42:43] sc1
  v_add_u32 v7, 3584, v7
  global_load_dword v54, v7, s[42:43] sc1
  v_add_u32 v7, 3584, v7
  global_load_dword v55, v7, s[42:43] sc1
  v_add_u32 v7, 3584, v7
  global_load_dword v56, v7, s[42:43] sc1
  v_add_u32 v7, 3584, v7
  global_load_dword v57, v7, s[42:43] sc1
  v_add_u32 v7, 3584, v7
  global_load_dword v58, v7, s[42:43] sc1
  v_add_u32 v7, 3584, v7
  global_load_dword v59, v7, s[42:43] sc1
  s_waitcnt vmcnt(0)
  v_max_u32 v8, v32, v33
  v_max3_u32 v8, v8, v34, v35
  v_max3_u32 v8, v8, v36, v37
  v_max3_u32 v8, v8, v38, v39
  v_max3_u32 v8, v8, v40, v41
  v_max3_u32 v8, v8, v42, v43
  v_max3_u32 v8, v8, v44, v45
  v_max3_u32 v8, v8, v46, v47
  v_max3_u32 v8, v8, v48, v49
  v_max3_u32 v8, v8, v50, v51
  v_max3_u32 v8, v8, v52, v53
  v_max3_u32 v8, v8, v54, v55
  v_max3_u32 v8, v8, v56, v57
  v_max3_u32 v8, v8, v58, v59
  v_cmp_eq_u32 vcc, -1, v8
  s_cbranch_vccz L_zd_38
  s_add_u32 s90, s90, 1
  s_cmp_ge_u32 s90, 200000
  s_cbranch_scc1 L_zd_38
  s_branch L_z_37
  s_nop 4
L_zd_38:
  s_waitcnt lgkmcnt(0)
  v_add_f32 v32, v32, v33
  v_add_f32 v32, v32, v34
  v_add_f32 v32, v32, v35
  v_add_f32 v32, v32, v36
  v_add_f32 v32, v32, v37
  v_add_f32 v32, v32, v38
  v_add_f32 v32, v32, v39
  v_add_f32 v32, v32, v40
  v_add_f32 v32, v32, v41
  v_add_f32 v32, v32, v42
  v_add_f32 v32, v32, v43
  v_add_f32 v32, v32, v44
  v_add_f32 v32, v32, v45
  v_add_f32 v32, v32, v46
  v_add_f32 v32, v32, v47
  v_add_f32 v32, v32, v48
  v_add_f32 v32, v32, v49
  v_add_f32 v32, v32, v50
  v_add_f32 v32, v32, v51
  v_add_f32 v32, v32, v52
  v_add_f32 v32, v32, v53
  v_add_f32 v32, v32, v54
  v_add_f32 v32, v32, v55
  v_add_f32 v32, v32, v56
  v_add_f32 v32, v32, v57
  v_add_f32 v32, v32, v58
  v_add_f32 v32, v32, v59
  v_cvt_pk_bf16_f32 v32, v32, v32
  v_lshlrev_b32 v32, 16, v32
  v_mul_f32 v32, v92, v32
  v_cvt_pk_bf16_f32 v32, v32, v32
  v_lshlrev_b32 v32, 16, v32
  v_add_f32 v32, v93, v32
  v_cvt_pk_bf16_f32 v32, v32, v32
  s_mov_b32 s44, s38
  s_and_b32 s45, s39, 0xffff
  s_mov_b32 s46, 1792
  s_mov_b32 s47, 0x20000
  v_lshlrev_b32 v4, 1, v4
  v_cmp_gt_u32 vcc, 32, v2
  s_nop 0
  s_and_saveexec_b64 s[8:9], vcc
  buffer_store_short v32, v4, s[44:47], 0 offen
  s_mov_b64 exec, -1
  s_nop 4
L_end:
  s_endpgm
.section .rodata,"a"
.p2align 6
.amdhsa_kernel adaLN_cond__mha_block_cached__geglu_ffn__decode_kernel
  .amdhsa_next_free_vgpr 128
  .amdhsa_next_free_sgpr 100
  .amdhsa_accum_offset 128
  .amdhsa_group_segment_fixed_size 0
  .amdhsa_kernarg_size 112
  .amdhsa_user_sgpr_count 2
  .amdhsa_user_sgpr_kernarg_segment_ptr 1
  .amdhsa_system_sgpr_workgroup_id_x 1
.end_amdhsa_kernel
```
